```python
import torch

def _softmax(x, axis=-1):
    return torch.softmax(x, dim=axis)
def _gelu(x):
    return torch.nn.functional.gelu(x, approximate="tanh")
def _silu(x):
    return torch.nn.functional.silu(x)
def _sigmoid(x):
    return torch.sigmoid(x)
def _layernorm(x, axis=-1, eps=1e-5):
    m = x.mean(dim=axis, keepdim=True)
    v = x.var(dim=axis, keepdim=True, unbiased=False)
    return (x - m) / torch.sqrt(v + eps)
def _scatter_add(tgt, idx, src, axis=0):
    return tgt.clone().index_add_(axis, idx, src)
def _segment_sum(src, seg, n):
    out = torch.zeros((n,) + src.shape[1:], dtype=src.dtype)
    return out.index_add_(0, seg, src)
def _pad(x, pw):
    flat = tuple(v for pair in reversed(pw) for v in pair)
    return torch.nn.functional.pad(x, flat)

kernel_name = 'parallel_sum__mha_block_cached__glu_gated_reglu__decode'

def setup_inputs():

    _w = (lambda a: (lambda t: t.to(torch.bfloat16) if t.is_floating_point() else t)(torch.as_tensor(a)))
    def _A_setup():
        B, Sq, D = 1, 1, 576
        H, Sk, Dh = 32, 8192, 128
        return {
            "x": _w((lambda *s: torch.randn(*s, dtype=torch.bfloat16) * 0.05)(B, Sq, D)),
            "k_cache": _w((lambda *s: torch.randn(*s, dtype=torch.bfloat16) * 1.6)(B, H, Sk, Dh)),
            "v_cache": _w((lambda *s: torch.randn(*s, dtype=torch.bfloat16) * 0.8)(B, H, Sk, Dh)),
            "wq": _w((lambda *s: torch.randn(*s, dtype=torch.bfloat16) * 1.6)(D, H * Dh) * (D ** -0.5)),
            "wo": _w((lambda *s: torch.randn(*s, dtype=torch.bfloat16) * 0.8)(H * Dh, D) * ((H * Dh) ** -0.5)),
        }
    _A_in = _A_setup()

    def _B_setup():
        B, S, D, F = 1, 1, 576, 4608
        return {
            "x": _w((lambda *s: torch.randn(*s, dtype=torch.bfloat16) * 0.05)(B, S, D)),
            "W_gate": _w((lambda *s: torch.randn(*s, dtype=torch.bfloat16) * 0.4)(D, F) * (2.0 / D) ** 0.5),
            "W_up": _w((lambda *s: torch.randn(*s, dtype=torch.bfloat16) * 0.4)(D, F) * (2.0 / D) ** 0.5),
            "W_down": _w((lambda *s: torch.randn(*s, dtype=torch.bfloat16) * 0.4)(F, D) * (1.0 / F) ** 0.5),
        }
    _B_in = _B_setup()

    return {
        "A_x": _A_in["x"],
        "A_k_cache": _A_in["k_cache"],
        "A_v_cache": _A_in["v_cache"],
        "A_wq": _A_in["wq"],
        "A_wo": _A_in["wo"],
        "B_x": _B_in["x"],
        "B_W_gate": _B_in["W_gate"],
        "B_W_up": _B_in["W_up"],
        "B_W_down": _B_in["W_down"],
    }

def reference(A_x, A_k_cache, A_v_cache, A_wq, A_wo, B_x, B_W_gate, B_W_up, B_W_down):
    def _A_ref(x, k_cache, v_cache, wq, wo):
        B, Sq, D = x.shape
        H, Dh = 32, 128
        q = (lambda x, *d: x.permute(*d))((x @ wq).reshape(B, Sq, H, Dh), 0, 2, 1, 3)
        scores = torch.einsum("bhqd,bhkd->bhqk", q, k_cache) * (Dh ** -0.5)
        p = _softmax(scores, axis=-1)
        o = torch.einsum("bhqk,bhkd->bhqd", p, v_cache)
        return (lambda x, *d: x.permute(*d))(o, 0, 2, 1, 3).reshape(B, Sq, H * Dh) @ wo

    def _B_ref(x, W_gate, W_up, W_down):
        gate = torch.einsum("bsd,df->bsf", x, W_gate)
        up = torch.einsum("bsd,df->bsf", x, W_up)
        gate = gate * (lambda x, dt: x.to(dt))(gate > 0, gate.dtype)
        h = gate * up
        return torch.einsum("bsf,fd->bsd", h, W_down)

    x = A_x
    xn = _layernorm(x, axis=-1)
    return x + _A_ref(xn, A_k_cache, A_v_cache, A_wq, A_wo) + _B_ref(xn, B_W_gate, B_W_up, B_W_down)
```

```asm
; @launch grid=(256,1,1) block=(256,1,1) lds=4608
.amdgcn_target "amdgcn-amd-amdhsa--gfx950"
.text
.globl parallel_sum__mha_block_cached__glu_gated_reglu__decode_kernel
.p2align 8
.type parallel_sum__mha_block_cached__glu_gated_reglu__decode_kernel,@function
parallel_sum__mha_block_cached__glu_gated_reglu__decode_kernel:
  s_cmp_ge_u32 s2, 256
  s_cbranch_scc1 L_end
  s_load_dwordx16 s[4:19], s[0:1], 0
  s_load_dwordx8 s[20:27], s[0:1], 64
  s_getpc_b64 s[60:61]
L_pc:
  v_lshrrev_b32 v4, 6, v0
  v_and_b32 v1, 63, v0
  s_lshr_b32 s65, s2, 3
  v_readfirstlane_b32 s64, v4
  v_lshl_add_u32 v5, s65, 2, v4
  v_lshlrev_b32 v5, 7, v5
  v_and_b32 v6, 1, v1
  v_lshl_add_u32 v5, v6, 6, v5
  v_min_u32 v5, L_end-L_pc, v5
  s_mov_b64 exec, 3
  global_load_dword v24, v5, s[60:61]
  s_mov_b64 exec, -1
  s_and_b32 s62, s2, 7
  s_lshl_b32 s62, s62, 2
  s_lshr_b32 s72, s2, 6
  s_and_b32 s63, s65, 7
  s_add_u32 s62, s62, s72
  v_lshrrev_b32 v2, 4, v1
  v_and_b32 v3, 15, v1
  v_add_u32 v4, s63, v3
  v_and_b32 v4, 7, v4
  v_mul_u32_u24 v4, 36, v4
  v_mul_u32_u24 v19, 288, v2
  v_add_u32 v19, v19, v4
  s_cmp_eq_u32 s64, 0
  s_movk_i32 s70, 0x2400
  s_cselect_b32 s70, 0x2000, s70
  s_mov_b32 s71, 0
  s_lshl_b32 s72, s64, 1
  s_lshr_b32 s72, 57, s72
  s_add_u32 s72, s72, s62
  s_and_b32 s72, s72, 3
  s_andn2_b32 s96, s62, 3
  s_or_b32 s96, s96, s72
  s_lshl_b32 s74, s96, 8
  s_lshl_b32 s75, s96, 5
  s_addk_i32 s75, 0x2000
  s_cmp_eq_u32 s64, 3
  s_cselect_b32 s74, s75, s74
  s_cselect_b32 s73, 1, 15
  s_mul_i32 s72, s63, 18
  v_mul_u32_u24 v4, 144, v2
  v_add_u32 v4, s72, v4
  v_mul_u32_u24 v4, s70, v4
  v_and_b32 v5, s73, v3
  v_lshl_add_u32 v4, v5, 4, v4
  v_add_u32 v30, s74, v4
  v_mov_b32 v31, 0
  v_and_b32 v5, 2, v3
  v_cmp_ne_u32 vcc, 0, v5
  s_mov_b32 s38, 1152
  s_mov_b32 s39, 0x20000
  s_waitcnt lgkmcnt(0)
  s_mov_b32 s36, s4
  s_mov_b32 s37, s5
  buffer_load_dwordx4 v[152:155], v19, s[36:39], 0 offen
  buffer_load_dwordx4 v[156:159], v19, s[36:39], 0 offen offset:16
  buffer_load_dword v160, v19, s[36:39], 0 offen offset:32
  s_cmp_eq_u32 s64, 0
  s_cselect_b64 s[66:67], s[10:11], s[16:17]
  s_cmp_eq_u32 s64, 2
  s_cselect_b64 s[66:67], s[18:19], s[66:67]
  s_cmp_eq_u32 s64, 3
  s_cselect_b64 s[68:69], s[18:19], s[66:67]
  v_mov_b32 v4, s66
  v_mov_b32 v5, s67
  v_mov_b32 v6, s68
  v_mov_b32 v7, s69
  v_cndmask_b32 v28, v4, v6, vcc
  v_cndmask_b32 v29, v5, v7, vcc
  v_lshl_add_u64 v[28:29], v[28:29], 0, v[30:31]
  global_load_dwordx4 v[164:167], v[28:29], off nt
  v_lshl_add_u64 v[28:29], v[28:29], 0, s[70:71]
  global_load_dwordx4 v[168:171], v[28:29], off nt
  v_lshl_add_u64 v[28:29], v[28:29], 0, s[70:71]
  global_load_dwordx4 v[172:175], v[28:29], off nt
  v_lshl_add_u64 v[28:29], v[28:29], 0, s[70:71]
  global_load_dwordx4 v[176:179], v[28:29], off nt
  v_lshl_add_u64 v[28:29], v[28:29], 0, s[70:71]
  global_load_dwordx4 v[180:183], v[28:29], off nt
  v_lshl_add_u64 v[28:29], v[28:29], 0, s[70:71]
  global_load_dwordx4 v[184:187], v[28:29], off nt
  v_lshl_add_u64 v[28:29], v[28:29], 0, s[70:71]
  global_load_dwordx4 v[188:191], v[28:29], off nt
  v_lshl_add_u64 v[28:29], v[28:29], 0, s[70:71]
  s_mov_b32 s48, s26
  s_mov_b32 s49, s27
  s_mov_b32 s50, 16777216
  s_mov_b32 s51, 0x20000
  s_mov_b32 s52, s22
  s_mov_b32 s53, s23
  s_mov_b32 s54, 1152
  s_mov_b32 s55, 0x20000
  s_mov_b32 s56, s24
  s_mov_b32 s57, s25
  s_mov_b32 s58, 256
  s_mov_b32 s59, 0x20000
  s_lshl_b32 s72, s62, 3
  s_add_u32 s72, s72, s63
  s_lshl_b32 s79, s72, 9
  s_add_u32 s79, s79, 524288
  s_lshl_b32 s83, s72, 7
  s_add_u32 s83, s83, 1572864
  s_lshl_b32 s78, s96, 3
  s_add_u32 s78, s78, s63
  s_lshl_b32 s78, s78, 11
  s_lshl_b32 s73, s64, 9
  s_add_u32 s78, s78, s73
  s_mul_i32 s82, s63, 12288
  s_add_u32 s82, s82, 1048576
  s_mul_i32 s73, s62, 384
  s_add_u32 s81, s82, s73
  s_cmp_eq_u32 s64, 1
  s_cselect_b32 s90, s81, s79
  s_cselect_b32 s73, 24, 32
  s_cmp_eq_u32 s64, 2
  s_cselect_b32 s90, s83, s90
  s_cselect_b32 s73, 8, s73
  s_cmp_eq_u32 s64, 3
  s_cselect_b32 s73, 0, s73
  s_cselect_b32 s74, 4, 16
  v_mov_b32 v7, 1073741824
  v_lshlrev_b32 v9, 4, v1
  v_cmp_gt_u32 vcc, s73, v1
  s_nop 1
  v_cndmask_b32 v15, v7, v9, vcc
  v_mov_b32 v108, -1
  v_mov_b32 v109, -1
  v_mov_b32 v110, -1
  v_mov_b32 v111, -1
  s_cmp_eq_u32 s64, 1
  s_cselect_b32 s75, 24, 0
  v_cmp_gt_u32 vcc, s75, v1
  s_nop 1
  v_cndmask_b32 v26, v7, v9, vcc
  buffer_store_dwordx4 v[108:111], v26, s[48:51], s90 offen sc0 sc1
  s_cselect_b32 s73, 0, s73
  v_cmp_gt_u32 vcc, s73, v1
  s_nop 1
  v_cndmask_b32 v15, v7, v9, vcc
  v_lshlrev_b32 v4, 5, v3
  v_lshl_add_u32 v4, v2, 4, v4
  s_lshl_b32 s73, s64, 9
  v_add_u32 v14, s73, v4
  v_cmp_gt_u32 vcc, 32, v1
  s_nop 1
  v_cndmask_b32 v11, v7, v4, vcc
  v_cmp_gt_u32 vcc, s74, v3
  s_nop 1
  v_cndmask_b32 v12, v7, v11, vcc
  v_cmp_gt_u32 vcc, 12, v3
  s_nop 1
  v_cndmask_b32 v13, v7, v11, vcc
  s_lshl_b32 s72, s62, 21
  s_lshl_b32 s73, s63, 18
  s_add_u32 s72, s72, s73
  s_mul_i32 s73, s64, 1024
  s_add_u32 s72, s72, s73
  s_add_u32 s28, s6, s72
  s_addc_u32 s29, s7, 0
  s_mov_b32 s30, 259072
  s_mov_b32 s31, 0x20000
  s_add_u32 s32, s8, s72
  s_addc_u32 s33, s9, 0
  s_mov_b32 s34, 259072
  s_mov_b32 s35, 0x20000
  v_and_b32 v4, 3, v3
  v_lshrrev_b32 v5, 2, v3
  v_lshlrev_b32 v8, 8, v5
  v_lshl_add_u32 v8, v2, 6, v8
  v_lshl_add_u32 v8, v4, 4, v8
  s_mul_i32 s72, s63, 144
  s_add_u32 s40, s12, s72
  s_addc_u32 s41, s13, 0
  s_sub_u32 s42, 4718592, s72
  s_mov_b32 s43, 0x20000
  s_add_u32 s44, s20, s72
  s_addc_u32 s45, s21, 0
  s_sub_u32 s46, 5308416, s72
  s_mov_b32 s47, 0x20000
  s_lshl_b32 s84, s62, 10
  s_add_u32 s84, s84, 1572864
  s_lshl_b32 s73, s64, 7
  s_lshl_b32 s80, s62, 14
  s_add_u32 s80, s80, s73
  s_lshl_b32 s92, s62, 12
  s_add_u32 s92, s92, s73
  s_add_u32 s92, s92, 524288
  s_lshl_b32 s73, s62, 5
  s_add_u32 s82, s82, s73
  s_mul_i32 s85, s63, 144
  s_lshl_b32 s73, s62, 4
  s_add_u32 s85, s85, s73
  s_getreg_b32 s88, hwreg(HW_REG_XCC_ID, 0, 4)
  s_mul_i32 s14, s88, s88
  s_lshl_b32 s14, s14, 10
  s_add_u32 s14, s14, s88
  s_lshl_b32 s14, s14, 10
  s_add_u32 s14, s14, 1
  v_lshlrev_b32 v4, 4, v3
  v_mad_u32_u24 v4, v2, s38, v4
  v_cmp_gt_u32 vcc, 9, v3
  s_nop 1
  v_cndmask_b32 v10, v7, v4, vcc
  v_lshlrev_b32 v4, 1, v2
  v_lshl_add_u32 v4, v3, 3, v4
  v_cmp_gt_u32 vcc, 2, v3
  s_nop 1
  v_cndmask_b32 v16, v7, v4, vcc
  v_lshrrev_b32 v4, 1, v1
  v_mul_u32_u24 v4, 384, v4
  v_and_b32 v5, 1, v1
  v_lshl_add_u32 v17, v5, 4, v4
  v_lshrrev_b32 v4, 3, v1
  v_and_b32 v5, 7, v1
  v_lshlrev_b32 v5, 4, v5
  v_lshl_add_u32 v18, v4, 9, v5
  v_lshlrev_b32 v4, 4, v1
  s_lshl_b32 s73, s64, 4
  v_add_u32 v26, s73, v4
  v_and_b32 v4, 1, v3
  v_lshlrev_b32 v4, 4, v4
  v_mov_b32 v5, 0xffff
  v_lshlrev_b32 v4, v4, v5
  v_lshrrev_b32 v5, 1, v3
  v_cmp_eq_u32 vcc, 0, v5
  s_nop 1
  v_cndmask_b32 v44, 0, v4, vcc
  v_cmp_eq_u32 vcc, 1, v5
  s_nop 1
  v_cndmask_b32 v45, 0, v4, vcc
  v_cmp_eq_u32 vcc, 2, v5
  s_nop 1
  v_cndmask_b32 v46, 0, v4, vcc
  v_cmp_eq_u32 vcc, 3, v5
  s_nop 1
  v_cndmask_b32 v47, 0, v4, vcc
  v_mov_b32 v38, s88
  v_mov_b32 v39, s88
  s_waitcnt vmcnt(8)
  v_lshlrev_b32 v132, 16, v152
  v_and_b32 v133, 0xffff0000, v152
  v_lshlrev_b32 v134, 16, v153
  v_and_b32 v135, 0xffff0000, v153
  v_lshlrev_b32 v136, 16, v154
  v_and_b32 v137, 0xffff0000, v154
  v_lshlrev_b32 v138, 16, v155
  v_and_b32 v139, 0xffff0000, v155
  v_lshlrev_b32 v140, 16, v156
  v_and_b32 v141, 0xffff0000, v156
  v_lshlrev_b32 v142, 16, v157
  v_and_b32 v143, 0xffff0000, v157
  v_lshlrev_b32 v144, 16, v158
  v_and_b32 v145, 0xffff0000, v158
  v_lshlrev_b32 v146, 16, v159
  v_and_b32 v147, 0xffff0000, v159
  v_lshlrev_b32 v148, 16, v160
  v_and_b32 v149, 0xffff0000, v160
  v_pk_add_f32 v[32:33], v[132:133], v[134:135]
  v_pk_add_f32 v[32:33], v[32:33], v[136:137]
  v_pk_add_f32 v[32:33], v[32:33], v[138:139]
  v_pk_add_f32 v[32:33], v[32:33], v[140:141]
  v_pk_add_f32 v[32:33], v[32:33], v[142:143]
  v_pk_add_f32 v[32:33], v[32:33], v[144:145]
  v_pk_add_f32 v[32:33], v[32:33], v[146:147]
  v_pk_add_f32 v[32:33], v[32:33], v[148:149]
  v_add_f32 v4, v32, v33
  s_nop 1
  v_add_f32_dpp v4, v4, v4 row_ror:8 row_mask:0xf bank_mask:0xf
  s_nop 1
  v_add_f32_dpp v4, v4, v4 row_ror:4 row_mask:0xf bank_mask:0xf
  s_nop 1
  v_add_f32_dpp v4, v4, v4 row_ror:2 row_mask:0xf bank_mask:0xf
  s_nop 1
  v_add_f32_dpp v4, v4, v4 row_ror:1 row_mask:0xf bank_mask:0xf
  v_mov_b32 v5, v4
  s_nop 1
  v_permlane16_swap_b32 v5, v4
  v_add_f32 v4, v5, v4
  v_mov_b32 v5, v4
  s_nop 1
  v_permlane32_swap_b32 v5, v4
  v_add_f32 v4, v5, v4
  v_mul_f32 v30, 0x3a638e39, v4
  v_mov_b32 v31, v30
  v_pk_add_f32 v[112:113], v[132:133], v[30:31] neg_lo:[0,1] neg_hi:[0,1]
  v_pk_add_f32 v[114:115], v[134:135], v[30:31] neg_lo:[0,1] neg_hi:[0,1]
  v_pk_add_f32 v[116:117], v[136:137], v[30:31] neg_lo:[0,1] neg_hi:[0,1]
  v_pk_add_f32 v[118:119], v[138:139], v[30:31] neg_lo:[0,1] neg_hi:[0,1]
  v_pk_add_f32 v[120:121], v[140:141], v[30:31] neg_lo:[0,1] neg_hi:[0,1]
  v_pk_add_f32 v[122:123], v[142:143], v[30:31] neg_lo:[0,1] neg_hi:[0,1]
  v_pk_add_f32 v[124:125], v[144:145], v[30:31] neg_lo:[0,1] neg_hi:[0,1]
  v_pk_add_f32 v[126:127], v[146:147], v[30:31] neg_lo:[0,1] neg_hi:[0,1]
  v_pk_add_f32 v[128:129], v[148:149], v[30:31] neg_lo:[0,1] neg_hi:[0,1]
  v_pk_mul_f32 v[32:33], v[112:113], v[112:113]
  v_pk_fma_f32 v[32:33], v[114:115], v[114:115], v[32:33]
  v_pk_fma_f32 v[32:33], v[116:117], v[116:117], v[32:33]
  v_pk_fma_f32 v[32:33], v[118:119], v[118:119], v[32:33]
  v_pk_fma_f32 v[32:33], v[120:121], v[120:121], v[32:33]
  v_pk_fma_f32 v[32:33], v[122:123], v[122:123], v[32:33]
  v_pk_fma_f32 v[32:33], v[124:125], v[124:125], v[32:33]
  v_pk_fma_f32 v[32:33], v[126:127], v[126:127], v[32:33]
  v_pk_fma_f32 v[32:33], v[128:129], v[128:129], v[32:33]
  v_add_f32 v4, v32, v33
  global_load_dwordx4 v[192:195], v[28:29], off nt
  v_lshl_add_u64 v[28:29], v[28:29], 0, s[70:71]
  global_load_dwordx4 v[196:199], v[28:29], off nt
  v_lshl_add_u64 v[28:29], v[28:29], 0, s[70:71]
  v_add_f32_dpp v4, v4, v4 row_ror:8 row_mask:0xf bank_mask:0xf
  s_nop 1
  v_add_f32_dpp v4, v4, v4 row_ror:4 row_mask:0xf bank_mask:0xf
  s_nop 1
  v_add_f32_dpp v4, v4, v4 row_ror:2 row_mask:0xf bank_mask:0xf
  s_nop 1
  v_add_f32_dpp v4, v4, v4 row_ror:1 row_mask:0xf bank_mask:0xf
  v_mov_b32 v5, v4
  s_nop 1
  v_permlane16_swap_b32 v5, v4
  v_add_f32 v4, v5, v4
  v_mov_b32 v5, v4
  s_nop 1
  v_permlane32_swap_b32 v5, v4
  v_add_f32 v4, v5, v4
  v_mul_f32 v4, 0x3a638e39, v4
  v_cvt_pk_bf16_f32 v4, v4, v4
  v_and_b32 v4, 0xffff0000, v4
  v_add_f32 v4, 0x3727c5ac, v4
  v_cvt_pk_bf16_f32 v4, v4, v4
  v_and_b32 v4, 0xffff0000, v4
  v_sqrt_f32 v4, v4
  s_nop 0
  v_cvt_pk_bf16_f32 v4, v4, v4
  v_and_b32 v4, 0xffff0000, v4
  v_rcp_f32 v32, v4
  v_cvt_pk_bf16_f32 v30, v30, v30
  v_and_b32 v30, 0xffff0000, v30
  v_mov_b32 v31, v30
  v_mov_b32 v33, v32
  v_pk_add_f32 v[132:133], v[132:133], v[30:31] neg_lo:[0,1] neg_hi:[0,1]
  v_pk_add_f32 v[134:135], v[134:135], v[30:31] neg_lo:[0,1] neg_hi:[0,1]
  v_pk_add_f32 v[136:137], v[136:137], v[30:31] neg_lo:[0,1] neg_hi:[0,1]
  v_pk_add_f32 v[138:139], v[138:139], v[30:31] neg_lo:[0,1] neg_hi:[0,1]
  v_pk_add_f32 v[140:141], v[140:141], v[30:31] neg_lo:[0,1] neg_hi:[0,1]
  v_pk_add_f32 v[142:143], v[142:143], v[30:31] neg_lo:[0,1] neg_hi:[0,1]
  v_pk_add_f32 v[144:145], v[144:145], v[30:31] neg_lo:[0,1] neg_hi:[0,1]
  v_pk_add_f32 v[146:147], v[146:147], v[30:31] neg_lo:[0,1] neg_hi:[0,1]
  v_pk_add_f32 v[148:149], v[148:149], v[30:31] neg_lo:[0,1] neg_hi:[0,1]
  v_cvt_pk_bf16_f32 v152, v132, v133
  v_cvt_pk_bf16_f32 v153, v134, v135
  v_cvt_pk_bf16_f32 v154, v136, v137
  v_cvt_pk_bf16_f32 v155, v138, v139
  v_cvt_pk_bf16_f32 v156, v140, v141
  v_cvt_pk_bf16_f32 v157, v142, v143
  v_cvt_pk_bf16_f32 v158, v144, v145
  v_cvt_pk_bf16_f32 v159, v146, v147
  v_cvt_pk_bf16_f32 v160, v148, v149
  global_load_dwordx4 v[200:203], v[28:29], off nt
  v_lshl_add_u64 v[28:29], v[28:29], 0, s[70:71]
  global_load_dwordx4 v[204:207], v[28:29], off nt
  v_lshl_add_u64 v[28:29], v[28:29], 0, s[70:71]
  v_lshlrev_b32 v132, 16, v152
  v_and_b32 v133, 0xffff0000, v152
  v_lshlrev_b32 v134, 16, v153
  v_and_b32 v135, 0xffff0000, v153
  v_lshlrev_b32 v136, 16, v154
  v_and_b32 v137, 0xffff0000, v154
  v_lshlrev_b32 v138, 16, v155
  v_and_b32 v139, 0xffff0000, v155
  v_lshlrev_b32 v140, 16, v156
  v_and_b32 v141, 0xffff0000, v156
  v_lshlrev_b32 v142, 16, v157
  v_and_b32 v143, 0xffff0000, v157
  v_lshlrev_b32 v144, 16, v158
  v_and_b32 v145, 0xffff0000, v158
  v_lshlrev_b32 v146, 16, v159
  v_and_b32 v147, 0xffff0000, v159
  v_lshlrev_b32 v148, 16, v160
  v_and_b32 v149, 0xffff0000, v160
  v_pk_mul_f32 v[132:133], v[132:133], v[32:33]
  v_pk_mul_f32 v[134:135], v[134:135], v[32:33]
  v_pk_mul_f32 v[136:137], v[136:137], v[32:33]
  v_pk_mul_f32 v[138:139], v[138:139], v[32:33]
  v_pk_mul_f32 v[140:141], v[140:141], v[32:33]
  v_pk_mul_f32 v[142:143], v[142:143], v[32:33]
  v_pk_mul_f32 v[144:145], v[144:145], v[32:33]
  v_pk_mul_f32 v[146:147], v[146:147], v[32:33]
  v_pk_mul_f32 v[148:149], v[148:149], v[32:33]
  v_cvt_pk_bf16_f32 v112, v132, v132
  v_cvt_pk_bf16_f32 v113, v133, v133
  v_cvt_pk_bf16_f32 v114, v134, v134
  v_cvt_pk_bf16_f32 v115, v135, v135
  v_cvt_pk_bf16_f32 v116, v136, v136
  v_cvt_pk_bf16_f32 v117, v137, v137
  v_cvt_pk_bf16_f32 v118, v138, v138
  v_cvt_pk_bf16_f32 v119, v139, v139
  v_cvt_pk_bf16_f32 v120, v140, v140
  v_cvt_pk_bf16_f32 v121, v141, v141
  v_cvt_pk_bf16_f32 v122, v142, v142
  v_cvt_pk_bf16_f32 v123, v143, v143
  v_cvt_pk_bf16_f32 v124, v144, v144
  v_cvt_pk_bf16_f32 v125, v145, v145
  v_cvt_pk_bf16_f32 v126, v146, v146
  v_cvt_pk_bf16_f32 v127, v147, v147
  v_cvt_pk_bf16_f32 v128, v148, v148
  v_cvt_pk_bf16_f32 v129, v149, v149
  s_waitcnt vmcnt(11)
  global_load_dwordx4 v[208:211], v[28:29], off nt
  v_lshl_add_u64 v[28:29], v[28:29], 0, s[70:71]
  v_and_b32_dpp v100, v112, v44 row_newbcast:0 row_mask:0xf bank_mask:0xf
  v_and_b32_dpp v101, v112, v45 row_newbcast:0 row_mask:0xf bank_mask:0xf
  v_and_b32_dpp v102, v112, v46 row_newbcast:0 row_mask:0xf bank_mask:0xf
  v_and_b32_dpp v103, v112, v47 row_newbcast:0 row_mask:0xf bank_mask:0xf
  s_nop 1
  v_mfma_f32_16x16x32_bf16 v[96:99], v[100:103], v[164:167], 0
  s_waitcnt vmcnt(11)
  global_load_dwordx4 v[212:215], v[28:29], off nt
  v_lshl_add_u64 v[28:29], v[28:29], 0, s[70:71]
  v_and_b32_dpp v104, v113, v44 row_newbcast:0 row_mask:0xf bank_mask:0xf
  v_and_b32_dpp v105, v113, v45 row_newbcast:0 row_mask:0xf bank_mask:0xf
  v_and_b32_dpp v106, v113, v46 row_newbcast:0 row_mask:0xf bank_mask:0xf
  v_and_b32_dpp v107, v113, v47 row_newbcast:0 row_mask:0xf bank_mask:0xf
  s_nop 1
  v_mfma_f32_16x16x32_bf16 v[96:99], v[104:107], v[168:171], v[96:99]
  s_waitcnt vmcnt(11)
  global_load_dwordx4 v[216:219], v[28:29], off nt
  v_lshl_add_u64 v[28:29], v[28:29], 0, s[70:71]
  v_and_b32_dpp v100, v114, v44 row_newbcast:0 row_mask:0xf bank_mask:0xf
  v_and_b32_dpp v101, v114, v45 row_newbcast:0 row_mask:0xf bank_mask:0xf
  v_and_b32_dpp v102, v114, v46 row_newbcast:0 row_mask:0xf bank_mask:0xf
  v_and_b32_dpp v103, v114, v47 row_newbcast:0 row_mask:0xf bank_mask:0xf
  s_nop 1
  v_mfma_f32_16x16x32_bf16 v[96:99], v[100:103], v[172:175], v[96:99]
  s_waitcnt vmcnt(11)
  global_load_dwordx4 v[220:223], v[28:29], off nt
  v_lshl_add_u64 v[28:29], v[28:29], 0, s[70:71]
  v_and_b32_dpp v104, v115, v44 row_newbcast:0 row_mask:0xf bank_mask:0xf
  v_and_b32_dpp v105, v115, v45 row_newbcast:0 row_mask:0xf bank_mask:0xf
  v_and_b32_dpp v106, v115, v46 row_newbcast:0 row_mask:0xf bank_mask:0xf
  v_and_b32_dpp v107, v115, v47 row_newbcast:0 row_mask:0xf bank_mask:0xf
  s_nop 1
  v_mfma_f32_16x16x32_bf16 v[96:99], v[104:107], v[176:179], v[96:99]
  s_waitcnt vmcnt(11)
  global_load_dwordx4 v[224:227], v[28:29], off nt
  v_lshl_add_u64 v[28:29], v[28:29], 0, s[70:71]
  v_and_b32_dpp v100, v116, v44 row_newbcast:0 row_mask:0xf bank_mask:0xf
  v_and_b32_dpp v101, v116, v45 row_newbcast:0 row_mask:0xf bank_mask:0xf
  v_and_b32_dpp v102, v116, v46 row_newbcast:0 row_mask:0xf bank_mask:0xf
  v_and_b32_dpp v103, v116, v47 row_newbcast:0 row_mask:0xf bank_mask:0xf
  s_nop 1
  v_mfma_f32_16x16x32_bf16 v[96:99], v[100:103], v[180:183], v[96:99]
  s_waitcnt vmcnt(11)
  global_load_dwordx4 v[228:231], v[28:29], off nt
  v_lshl_add_u64 v[28:29], v[28:29], 0, s[70:71]
  v_and_b32_dpp v104, v117, v44 row_newbcast:0 row_mask:0xf bank_mask:0xf
  v_and_b32_dpp v105, v117, v45 row_newbcast:0 row_mask:0xf bank_mask:0xf
  v_and_b32_dpp v106, v117, v46 row_newbcast:0 row_mask:0xf bank_mask:0xf
  v_and_b32_dpp v107, v117, v47 row_newbcast:0 row_mask:0xf bank_mask:0xf
  s_nop 1
  v_mfma_f32_16x16x32_bf16 v[96:99], v[104:107], v[184:187], v[96:99]
  s_waitcnt vmcnt(11)
  global_load_dwordx4 v[232:235], v[28:29], off nt
  v_and_b32_dpp v100, v118, v44 row_newbcast:0 row_mask:0xf bank_mask:0xf
  v_and_b32_dpp v101, v118, v45 row_newbcast:0 row_mask:0xf bank_mask:0xf
  v_and_b32_dpp v102, v118, v46 row_newbcast:0 row_mask:0xf bank_mask:0xf
  v_and_b32_dpp v103, v118, v47 row_newbcast:0 row_mask:0xf bank_mask:0xf
  s_nop 1
  v_mfma_f32_16x16x32_bf16 v[96:99], v[100:103], v[188:191], v[96:99]
  s_waitcnt vmcnt(11)
  s_mov_b32 s76, 0
  buffer_load_dwordx4 a[0:3], v8, s[28:31], s76 offen offset:0 nt
  v_and_b32_dpp v104, v119, v44 row_newbcast:0 row_mask:0xf bank_mask:0xf
  v_and_b32_dpp v105, v119, v45 row_newbcast:0 row_mask:0xf bank_mask:0xf
  v_and_b32_dpp v106, v119, v46 row_newbcast:0 row_mask:0xf bank_mask:0xf
  v_and_b32_dpp v107, v119, v47 row_newbcast:0 row_mask:0xf bank_mask:0xf
  s_waitcnt vmcnt(11)
  s_nop 0
  v_mfma_f32_16x16x32_bf16 v[96:99], v[104:107], v[192:195], v[96:99]
  s_mov_b32 s76, 4096
  buffer_load_dwordx4 a[4:7], v8, s[28:31], s76 offen offset:0 nt
  v_and_b32_dpp v100, v120, v44 row_newbcast:0 row_mask:0xf bank_mask:0xf
  v_and_b32_dpp v101, v120, v45 row_newbcast:0 row_mask:0xf bank_mask:0xf
  v_and_b32_dpp v102, v120, v46 row_newbcast:0 row_mask:0xf bank_mask:0xf
  v_and_b32_dpp v103, v120, v47 row_newbcast:0 row_mask:0xf bank_mask:0xf
  s_waitcnt vmcnt(11)
  s_nop 0
  v_mfma_f32_16x16x32_bf16 v[96:99], v[100:103], v[196:199], v[96:99]
  s_mov_b32 s76, 8192
  buffer_load_dwordx4 a[8:11], v8, s[28:31], s76 offen offset:0 nt
  v_and_b32_dpp v104, v121, v44 row_newbcast:0 row_mask:0xf bank_mask:0xf
  v_and_b32_dpp v105, v121, v45 row_newbcast:0 row_mask:0xf bank_mask:0xf
  v_and_b32_dpp v106, v121, v46 row_newbcast:0 row_mask:0xf bank_mask:0xf
  v_and_b32_dpp v107, v121, v47 row_newbcast:0 row_mask:0xf bank_mask:0xf
  s_waitcnt vmcnt(11)
  s_nop 0
  v_mfma_f32_16x16x32_bf16 v[96:99], v[104:107], v[200:203], v[96:99]
  s_mov_b32 s76, 12288
  buffer_load_dwordx4 a[12:15], v8, s[28:31], s76 offen offset:0 nt
  v_and_b32_dpp v100, v122, v44 row_newbcast:0 row_mask:0xf bank_mask:0xf
  v_and_b32_dpp v101, v122, v45 row_newbcast:0 row_mask:0xf bank_mask:0xf
  v_and_b32_dpp v102, v122, v46 row_newbcast:0 row_mask:0xf bank_mask:0xf
  v_and_b32_dpp v103, v122, v47 row_newbcast:0 row_mask:0xf bank_mask:0xf
  s_waitcnt vmcnt(11)
  s_nop 0
  v_mfma_f32_16x16x32_bf16 v[96:99], v[100:103], v[204:207], v[96:99]
  s_mov_b32 s76, 16384
  buffer_load_dwordx4 a[16:19], v8, s[28:31], s76 offen offset:0 nt
  v_and_b32_dpp v104, v123, v44 row_newbcast:0 row_mask:0xf bank_mask:0xf
  v_and_b32_dpp v105, v123, v45 row_newbcast:0 row_mask:0xf bank_mask:0xf
  v_and_b32_dpp v106, v123, v46 row_newbcast:0 row_mask:0xf bank_mask:0xf
  v_and_b32_dpp v107, v123, v47 row_newbcast:0 row_mask:0xf bank_mask:0xf
  s_waitcnt vmcnt(11)
  s_nop 0
  v_mfma_f32_16x16x32_bf16 v[96:99], v[104:107], v[208:211], v[96:99]
  s_mov_b32 s76, 20480
  buffer_load_dwordx4 a[20:23], v8, s[28:31], s76 offen offset:0 nt
  v_and_b32_dpp v100, v124, v44 row_newbcast:0 row_mask:0xf bank_mask:0xf
  v_and_b32_dpp v101, v124, v45 row_newbcast:0 row_mask:0xf bank_mask:0xf
  v_and_b32_dpp v102, v124, v46 row_newbcast:0 row_mask:0xf bank_mask:0xf
  v_and_b32_dpp v103, v124, v47 row_newbcast:0 row_mask:0xf bank_mask:0xf
  s_waitcnt vmcnt(11)
  s_nop 0
  v_mfma_f32_16x16x32_bf16 v[96:99], v[100:103], v[212:215], v[96:99]
  s_mov_b32 s76, 24576
  buffer_load_dwordx4 a[24:27], v8, s[28:31], s76 offen offset:0 nt
  v_and_b32_dpp v104, v125, v44 row_newbcast:0 row_mask:0xf bank_mask:0xf
  v_and_b32_dpp v105, v125, v45 row_newbcast:0 row_mask:0xf bank_mask:0xf
  v_and_b32_dpp v106, v125, v46 row_newbcast:0 row_mask:0xf bank_mask:0xf
  v_and_b32_dpp v107, v125, v47 row_newbcast:0 row_mask:0xf bank_mask:0xf
  s_waitcnt vmcnt(11)
  s_nop 0
  v_mfma_f32_16x16x32_bf16 v[96:99], v[104:107], v[216:219], v[96:99]
  s_mov_b32 s76, 28672
  buffer_load_dwordx4 a[28:31], v8, s[28:31], s76 offen offset:0 nt
  v_and_b32_dpp v100, v126, v44 row_newbcast:0 row_mask:0xf bank_mask:0xf
  v_and_b32_dpp v101, v126, v45 row_newbcast:0 row_mask:0xf bank_mask:0xf
  v_and_b32_dpp v102, v126, v46 row_newbcast:0 row_mask:0xf bank_mask:0xf
  v_and_b32_dpp v103, v126, v47 row_newbcast:0 row_mask:0xf bank_mask:0xf
  s_waitcnt vmcnt(11)
  s_nop 0
  v_mfma_f32_16x16x32_bf16 v[96:99], v[100:103], v[220:223], v[96:99]
  s_mov_b32 s76, 32768
  buffer_load_dwordx4 a[32:35], v8, s[28:31], s76 offen offset:0 nt
  v_and_b32_dpp v104, v127, v44 row_newbcast:0 row_mask:0xf bank_mask:0xf
  v_and_b32_dpp v105, v127, v45 row_newbcast:0 row_mask:0xf bank_mask:0xf
  v_and_b32_dpp v106, v127, v46 row_newbcast:0 row_mask:0xf bank_mask:0xf
  v_and_b32_dpp v107, v127, v47 row_newbcast:0 row_mask:0xf bank_mask:0xf
  s_waitcnt vmcnt(11)
  s_nop 0
  v_mfma_f32_16x16x32_bf16 v[96:99], v[104:107], v[224:227], v[96:99]
  s_mov_b32 s76, 36864
  buffer_load_dwordx4 a[36:39], v8, s[28:31], s76 offen offset:0 nt
  v_and_b32_dpp v100, v128, v44 row_newbcast:0 row_mask:0xf bank_mask:0xf
  v_and_b32_dpp v101, v128, v45 row_newbcast:0 row_mask:0xf bank_mask:0xf
  v_and_b32_dpp v102, v128, v46 row_newbcast:0 row_mask:0xf bank_mask:0xf
  v_and_b32_dpp v103, v128, v47 row_newbcast:0 row_mask:0xf bank_mask:0xf
  s_waitcnt vmcnt(11)
  s_nop 0
  v_mfma_f32_16x16x32_bf16 v[96:99], v[100:103], v[228:231], v[96:99]
  s_mov_b32 s76, 40960
  buffer_load_dwordx4 a[40:43], v8, s[28:31], s76 offen offset:0 nt
  v_and_b32_dpp v104, v129, v44 row_newbcast:0 row_mask:0xf bank_mask:0xf
  v_and_b32_dpp v105, v129, v45 row_newbcast:0 row_mask:0xf bank_mask:0xf
  v_and_b32_dpp v106, v129, v46 row_newbcast:0 row_mask:0xf bank_mask:0xf
  v_and_b32_dpp v107, v129, v47 row_newbcast:0 row_mask:0xf bank_mask:0xf
  s_waitcnt vmcnt(11)
  s_nop 0
  v_mfma_f32_16x16x32_bf16 v[96:99], v[104:107], v[232:235], v[96:99]
  buffer_store_dwordx4 v[108:111], v15, s[48:51], s90 offen
  s_nop 6
  buffer_store_dwordx4 v[96:99], v12, s[48:51], s78 offen
  s_waitcnt vmcnt(11)
  s_mov_b32 s76, 45056
  buffer_load_dwordx4 a[44:47], v8, s[28:31], s76 offen offset:0 nt
  s_waitcnt vmcnt(11)
  s_mov_b32 s76, 49152
  buffer_load_dwordx4 a[48:51], v8, s[28:31], s76 offen offset:0 nt
  s_waitcnt vmcnt(11)
  s_mov_b32 s76, 53248
  buffer_load_dwordx4 a[52:55], v8, s[28:31], s76 offen offset:0 nt
  s_waitcnt vmcnt(11)
  s_mov_b32 s76, 57344
  buffer_load_dwordx4 a[56:59], v8, s[28:31], s76 offen offset:0 nt
  s_waitcnt vmcnt(11)
  s_mov_b32 s76, 61440
  buffer_load_dwordx4 a[60:63], v8, s[28:31], s76 offen offset:0 nt
  s_waitcnt vmcnt(11)
  s_mov_b32 s76, 65536
  buffer_load_dwordx4 a[64:67], v8, s[28:31], s76 offen offset:0 nt
  s_waitcnt vmcnt(11)
  s_mov_b32 s76, 69632
  buffer_load_dwordx4 a[68:71], v8, s[28:31], s76 offen offset:0 nt
  s_waitcnt vmcnt(11)
  s_mov_b32 s76, 73728
  buffer_load_dwordx4 a[72:75], v8, s[28:31], s76 offen offset:0 nt
  s_waitcnt vmcnt(11)
  s_mov_b32 s76, 77824
  buffer_load_dwordx4 a[76:79], v8, s[28:31], s76 offen offset:0 nt
  s_waitcnt vmcnt(11)
  s_mov_b32 s76, 81920
  buffer_load_dwordx4 a[80:83], v8, s[28:31], s76 offen offset:0 nt
  s_waitcnt vmcnt(11)
  s_mov_b32 s76, 86016
  buffer_load_dwordx4 a[84:87], v8, s[28:31], s76 offen offset:0 nt
  s_waitcnt vmcnt(11)
  s_mov_b32 s76, 90112
  buffer_load_dwordx4 a[88:91], v8, s[28:31], s76 offen offset:0 nt
  s_barrier
  s_lshl_b32 s91, s62, 3
  s_andn2_b32 s97, s91, 31
  s_cmp_lg_u32 s64, 0
  s_cbranch_scc1 L_noflag
  s_mov_b32 s93, s14
  s_atomic_add s93, s[24:25], s91
L_noflag:
  s_waitcnt vmcnt(11)
  s_mov_b32 s76, 94208
  buffer_load_dwordx4 a[92:95], v8, s[28:31], s76 offen offset:0 nt
  s_waitcnt vmcnt(11)
  s_mov_b32 s76, 98304
  buffer_load_dwordx4 a[96:99], v8, s[28:31], s76 offen offset:0 nt
  s_waitcnt vmcnt(11)
  s_mov_b32 s76, 102400
  buffer_load_dwordx4 a[100:103], v8, s[28:31], s76 offen offset:0 nt
  s_waitcnt vmcnt(11)
  s_mov_b32 s76, 106496
  buffer_load_dwordx4 a[104:107], v8, s[28:31], s76 offen offset:0 nt
  s_waitcnt vmcnt(11)
  s_mov_b32 s76, 110592
  buffer_load_dwordx4 a[108:111], v8, s[28:31], s76 offen offset:0 nt
  s_waitcnt vmcnt(11)
  s_mov_b32 s76, 114688
  buffer_load_dwordx4 a[112:115], v8, s[28:31], s76 offen offset:0 nt
  s_waitcnt vmcnt(11)
  s_mov_b32 s76, 118784
  buffer_load_dwordx4 a[116:119], v8, s[28:31], s76 offen offset:0 nt
  s_waitcnt vmcnt(11)
  s_mov_b32 s76, 122880
  buffer_load_dwordx4 a[120:123], v8, s[28:31], s76 offen offset:0 nt
  s_waitcnt vmcnt(11)
  s_mov_b32 s76, 126976
  buffer_load_dwordx4 a[124:127], v8, s[28:31], s76 offen offset:0 nt
  s_waitcnt vmcnt(11)
  s_mov_b32 s76, 131072
  buffer_load_dwordx4 a[128:131], v8, s[28:31], s76 offen offset:0 nt
  s_waitcnt vmcnt(11)
  s_mov_b32 s76, 135168
  buffer_load_dwordx4 a[132:135], v8, s[28:31], s76 offen offset:0 nt
  s_waitcnt vmcnt(11)
  s_mov_b32 s76, 139264
  buffer_load_dwordx4 a[136:139], v8, s[28:31], s76 offen offset:0 nt
  s_waitcnt vmcnt(11)
  s_mov_b32 s76, 143360
  buffer_load_dwordx4 a[140:143], v8, s[28:31], s76 offen offset:0 nt
  s_waitcnt vmcnt(11)
  s_mov_b32 s76, 147456
  buffer_load_dwordx4 a[144:147], v8, s[28:31], s76 offen offset:0 nt
  s_waitcnt vmcnt(11)
  s_mov_b32 s76, 151552
  buffer_load_dwordx4 a[148:151], v8, s[28:31], s76 offen offset:0 nt
  s_waitcnt vmcnt(11)
  s_mov_b32 s76, 155648
  buffer_load_dwordx4 a[152:155], v8, s[28:31], s76 offen offset:0 nt
  s_waitcnt vmcnt(11)
  s_mov_b32 s76, 159744
  buffer_load_dwordx4 a[156:159], v8, s[28:31], s76 offen offset:0 nt
  s_waitcnt vmcnt(11)
  s_mov_b32 s76, 163840
  buffer_load_dwordx4 a[160:163], v8, s[28:31], s76 offen offset:0 nt
  s_lshl_b32 s14, s14, 3
  s_mov_b32 s89, 1
  s_load_dwordx8 s[4:11], s[24:25], s97
  s_waitcnt vmcnt(11)
  s_mov_b32 s76, 167936
  buffer_load_dwordx4 a[164:167], v8, s[28:31], s76 offen offset:0 nt
  s_waitcnt vmcnt(11)
  s_mov_b32 s76, 172032
  buffer_load_dwordx4 a[168:171], v8, s[28:31], s76 offen offset:0 nt
  s_waitcnt vmcnt(11)
  s_mov_b32 s76, 176128
  buffer_load_dwordx4 a[172:175], v8, s[28:31], s76 offen offset:0 nt
  s_waitcnt vmcnt(11)
  s_mov_b32 s76, 180224
  buffer_load_dwordx4 a[176:179], v8, s[28:31], s76 offen offset:0 nt
  s_waitcnt lgkmcnt(0)
  s_xor_b32 s4, s4, s14
  s_xor_b32 s6, s6, s14
  s_xor_b32 s8, s8, s14
  s_xor_b32 s10, s10, s14
  s_or_b32 s4, s4, s6
  s_or_b32 s8, s8, s10
  s_or_b32 s4, s4, s8
  s_cbranch_scc1 L_r1
L_c1:
  v_lshrrev_b32 v4, 2, v3
  v_lshlrev_b32 v4, 12, v4
  v_and_b32 v5, 3, v3
  v_lshl_add_u32 v4, v5, 5, v4
  v_lshl_add_u32 v4, v2, 7, v4
  s_lshl_b32 s72, s62, 14
  buffer_load_dwordx4 v[132:135], v4, s[48:51], s72 offen offset:0 sc1
  buffer_load_dwordx4 v[136:139], v4, s[48:51], s72 offen offset:16 sc1
  buffer_load_dwordx4 v[140:143], v4, s[48:51], s72 offen offset:2048 sc1
  buffer_load_dwordx4 v[144:147], v4, s[48:51], s72 offen offset:2064 sc1
  s_waitcnt vmcnt(11)
  s_mov_b32 s76, 184320
  buffer_load_dwordx4 a[180:183], v8, s[28:31], s76 offen offset:0 nt
  s_waitcnt vmcnt(11)
  s_mov_b32 s76, 188416
  buffer_load_dwordx4 a[184:187], v8, s[28:31], s76 offen offset:0 nt
  s_waitcnt vmcnt(11)
  s_mov_b32 s76, 192512
  buffer_load_dwordx4 a[188:191], v8, s[28:31], s76 offen offset:0 nt
  s_waitcnt vmcnt(11)
  s_mov_b32 s76, 196608
  buffer_load_dwordx4 a[192:195], v8, s[28:31], s76 offen offset:0 nt
  s_waitcnt vmcnt(11)
  s_mov_b32 s76, 200704
  buffer_load_dwordx4 a[196:199], v8, s[28:31], s76 offen offset:0 nt
  s_waitcnt vmcnt(11)
  s_mov_b32 s76, 204800
  buffer_load_dwordx4 a[200:203], v8, s[28:31], s76 offen offset:0 nt
  s_waitcnt vmcnt(11)
  s_mov_b32 s76, 208896
  buffer_load_dwordx4 a[204:207], v8, s[28:31], s76 offen offset:0 nt
  s_waitcnt vmcnt(11)
  s_mov_b32 s76, 212992
  buffer_load_dwordx4 a[208:211], v8, s[28:31], s76 offen offset:0 nt
  s_waitcnt vmcnt(11)
  s_mov_b32 s76, 217088
  buffer_load_dwordx4 a[212:215], v8, s[28:31], s76 offen offset:0 nt
  s_waitcnt vmcnt(11)
  s_mov_b32 s76, 221184
  buffer_load_dwordx4 a[216:219], v8, s[28:31], s76 offen offset:0 nt
  s_waitcnt vmcnt(11)
  s_mov_b32 s76, 225280
  buffer_load_dwordx4 a[220:223], v8, s[28:31], s76 offen offset:0 nt
  s_waitcnt vmcnt(11)
  s_mov_b32 s76, 229376
  buffer_load_dwordx4 a[224:227], v8, s[28:31], s76 offen offset:0 nt
  v_pk_add_f32 v[132:133], v[132:133], v[140:141]
  v_pk_add_f32 v[134:135], v[134:135], v[142:143]
  v_pk_add_f32 v[136:137], v[136:137], v[144:145]
  v_pk_add_f32 v[138:139], v[138:139], v[146:147]
  v_add_f32_dpp v132, v132, v132 row_ror:4 row_mask:0xf bank_mask:0xf
  v_add_f32_dpp v133, v133, v133 row_ror:4 row_mask:0xf bank_mask:0xf
  v_add_f32_dpp v134, v134, v134 row_ror:4 row_mask:0xf bank_mask:0xf
  v_add_f32_dpp v135, v135, v135 row_ror:4 row_mask:0xf bank_mask:0xf
  v_add_f32_dpp v136, v136, v136 row_ror:4 row_mask:0xf bank_mask:0xf
  v_add_f32_dpp v137, v137, v137 row_ror:4 row_mask:0xf bank_mask:0xf
  v_add_f32_dpp v138, v138, v138 row_ror:4 row_mask:0xf bank_mask:0xf
  v_add_f32_dpp v139, v139, v139 row_ror:4 row_mask:0xf bank_mask:0xf
  v_add_f32_dpp v132, v132, v132 row_ror:8 row_mask:0xf bank_mask:0xf
  v_add_f32_dpp v133, v133, v133 row_ror:8 row_mask:0xf bank_mask:0xf
  v_add_f32_dpp v134, v134, v134 row_ror:8 row_mask:0xf bank_mask:0xf
  v_add_f32_dpp v135, v135, v135 row_ror:8 row_mask:0xf bank_mask:0xf
  v_add_f32_dpp v136, v136, v136 row_ror:8 row_mask:0xf bank_mask:0xf
  v_add_f32_dpp v137, v137, v137 row_ror:8 row_mask:0xf bank_mask:0xf
  v_add_f32_dpp v138, v138, v138 row_ror:8 row_mask:0xf bank_mask:0xf
  v_add_f32_dpp v139, v139, v139 row_ror:8 row_mask:0xf bank_mask:0xf
  v_cvt_pk_bf16_f32 v140, v132, v133
  v_cvt_pk_bf16_f32 v141, v134, v135
  v_cvt_pk_bf16_f32 v142, v136, v137
  v_cvt_pk_bf16_f32 v143, v138, v139
  v_lshrrev_b32 v4, 2, v3
  v_cmp_eq_u32 vcc, 0, v4
  s_nop 1
  v_cndmask_b32 v64, 0, v140, vcc
  v_cndmask_b32 v65, 0, v141, vcc
  v_cndmask_b32 v66, 0, v142, vcc
  v_cndmask_b32 v67, 0, v143, vcc
  v_cmp_eq_u32 vcc, 1, v4
  s_nop 1
  v_cndmask_b32 v68, 0, v140, vcc
  v_cndmask_b32 v69, 0, v141, vcc
  v_cndmask_b32 v70, 0, v142, vcc
  v_cndmask_b32 v71, 0, v143, vcc
  v_cmp_eq_u32 vcc, 2, v4
  s_nop 1
  v_cndmask_b32 v72, 0, v140, vcc
  v_cndmask_b32 v73, 0, v141, vcc
  v_cndmask_b32 v74, 0, v142, vcc
  v_cndmask_b32 v75, 0, v143, vcc
  v_cmp_eq_u32 vcc, 3, v4
  s_nop 1
  v_cndmask_b32 v76, 0, v140, vcc
  v_cndmask_b32 v77, 0, v141, vcc
  v_cndmask_b32 v78, 0, v142, vcc
  v_cndmask_b32 v79, 0, v143, vcc
  v_mov_b32 v20, 0xff800000
  v_mfma_f32_16x16x32_bf16 v[80:83], a[0:3], v[64:67], 0
  v_mfma_f32_16x16x32_bf16 v[80:83], a[4:7], v[68:71], v[80:83]
  v_mfma_f32_16x16x32_bf16 v[80:83], a[8:11], v[72:75], v[80:83]
  v_mfma_f32_16x16x32_bf16 v[80:83], a[12:15], v[76:79], v[80:83]
  v_mfma_f32_16x16x32_bf16 v[84:87], a[16:19], v[64:67], 0
  v_mfma_f32_16x16x32_bf16 v[84:87], a[20:23], v[68:71], v[84:87]
  s_waitcnt vmcnt(11)
  s_mov_b32 s76, 233472
  buffer_load_dwordx4 a[228:231], v8, s[28:31], s76 offen offset:0 nt
  v_mfma_f32_16x16x32_bf16 v[84:87], a[24:27], v[72:75], v[84:87]
  v_mfma_f32_16x16x32_bf16 v[84:87], a[28:31], v[76:79], v[84:87]
  s_nop 0
  v_add_f32_dpp v4, v81, v80 quad_perm:[1,1,1,1] row_mask:0xf bank_mask:0xf
  v_add_f32_dpp v5, v83, v82 quad_perm:[3,3,3,3] row_mask:0xf bank_mask:0xf
  s_nop 1
  v_add_f32_dpp v48, v5, v4 quad_perm:[2,2,2,2] row_mask:0xf bank_mask:0xf
  v_cvt_pk_bf16_f32 v48, v48, v48
  v_and_b32 v48, 0xffff0000, v48
  v_mul_f32 v48, 0x3db504f3, v48
  v_cvt_pk_bf16_f32 v48, v48, v48
  v_and_b32 v48, 0xffff0000, v48
  v_max_f32 v20, v20, v48
  v_mfma_f32_16x16x32_bf16 v[80:83], a[32:35], v[64:67], 0
  v_mfma_f32_16x16x32_bf16 v[80:83], a[36:39], v[68:71], v[80:83]
  v_mfma_f32_16x16x32_bf16 v[80:83], a[40:43], v[72:75], v[80:83]
  v_mfma_f32_16x16x32_bf16 v[80:83], a[44:47], v[76:79], v[80:83]
  v_add_f32_dpp v4, v85, v84 quad_perm:[1,1,1,1] row_mask:0xf bank_mask:0xf
  v_add_f32_dpp v5, v87, v86 quad_perm:[3,3,3,3] row_mask:0xf bank_mask:0xf
  s_nop 1
  v_add_f32_dpp v49, v5, v4 quad_perm:[2,2,2,2] row_mask:0xf bank_mask:0xf
  v_cvt_pk_bf16_f32 v49, v49, v49
  v_and_b32 v49, 0xffff0000, v49
  v_mul_f32 v49, 0x3db504f3, v49
  v_cvt_pk_bf16_f32 v49, v49, v49
  v_and_b32 v49, 0xffff0000, v49
  v_max_f32 v20, v20, v49
  s_waitcnt vmcnt(11)
  s_mov_b32 s76, 237568
  buffer_load_dwordx4 a[232:235], v8, s[28:31], s76 offen offset:0 nt
  v_mfma_f32_16x16x32_bf16 v[84:87], a[48:51], v[64:67], 0
  v_mfma_f32_16x16x32_bf16 v[84:87], a[52:55], v[68:71], v[84:87]
  v_mfma_f32_16x16x32_bf16 v[84:87], a[56:59], v[72:75], v[84:87]
  v_mfma_f32_16x16x32_bf16 v[84:87], a[60:63], v[76:79], v[84:87]
  v_add_f32_dpp v4, v81, v80 quad_perm:[1,1,1,1] row_mask:0xf bank_mask:0xf
  v_add_f32_dpp v5, v83, v82 quad_perm:[3,3,3,3] row_mask:0xf bank_mask:0xf
  s_nop 1
  v_add_f32_dpp v50, v5, v4 quad_perm:[2,2,2,2] row_mask:0xf bank_mask:0xf
  v_cvt_pk_bf16_f32 v50, v50, v50
  v_and_b32 v50, 0xffff0000, v50
  v_mul_f32 v50, 0x3db504f3, v50
  v_cvt_pk_bf16_f32 v50, v50, v50
  v_and_b32 v50, 0xffff0000, v50
  v_max_f32 v20, v20, v50
  v_mfma_f32_16x16x32_bf16 v[80:83], a[64:67], v[64:67], 0
  v_mfma_f32_16x16x32_bf16 v[80:83], a[68:71], v[68:71], v[80:83]
  s_waitcnt vmcnt(11)
  s_mov_b32 s76, 241664
  buffer_load_dwordx4 a[236:239], v8, s[28:31], s76 offen offset:0 nt
  v_mfma_f32_16x16x32_bf16 v[80:83], a[72:75], v[72:75], v[80:83]
  v_mfma_f32_16x16x32_bf16 v[80:83], a[76:79], v[76:79], v[80:83]
  v_add_f32_dpp v4, v85, v84 quad_perm:[1,1,1,1] row_mask:0xf bank_mask:0xf
  v_add_f32_dpp v5, v87, v86 quad_perm:[3,3,3,3] row_mask:0xf bank_mask:0xf
  s_nop 1
  v_add_f32_dpp v51, v5, v4 quad_perm:[2,2,2,2] row_mask:0xf bank_mask:0xf
  v_cvt_pk_bf16_f32 v51, v51, v51
  v_and_b32 v51, 0xffff0000, v51
  v_mul_f32 v51, 0x3db504f3, v51
  v_cvt_pk_bf16_f32 v51, v51, v51
  v_and_b32 v51, 0xffff0000, v51
  v_max_f32 v20, v20, v51
  v_mfma_f32_16x16x32_bf16 v[84:87], a[80:83], v[64:67], 0
  v_mfma_f32_16x16x32_bf16 v[84:87], a[84:87], v[68:71], v[84:87]
  v_mfma_f32_16x16x32_bf16 v[84:87], a[88:91], v[72:75], v[84:87]
  v_mfma_f32_16x16x32_bf16 v[84:87], a[92:95], v[76:79], v[84:87]
  v_add_f32_dpp v4, v81, v80 quad_perm:[1,1,1,1] row_mask:0xf bank_mask:0xf
  v_add_f32_dpp v5, v83, v82 quad_perm:[3,3,3,3] row_mask:0xf bank_mask:0xf
  s_nop 1
  v_add_f32_dpp v52, v5, v4 quad_perm:[2,2,2,2] row_mask:0xf bank_mask:0xf
  v_cvt_pk_bf16_f32 v52, v52, v52
  v_and_b32 v52, 0xffff0000, v52
  v_mul_f32 v52, 0x3db504f3, v52
  v_cvt_pk_bf16_f32 v52, v52, v52
  v_and_b32 v52, 0xffff0000, v52
  v_max_f32 v20, v20, v52
  s_waitcnt vmcnt(11)
  s_mov_b32 s76, 245760
  buffer_load_dwordx4 a[240:243], v8, s[28:31], s76 offen offset:0 nt
  v_mfma_f32_16x16x32_bf16 v[80:83], a[96:99], v[64:67], 0
  v_mfma_f32_16x16x32_bf16 v[80:83], a[100:103], v[68:71], v[80:83]
  v_mfma_f32_16x16x32_bf16 v[80:83], a[104:107], v[72:75], v[80:83]
  v_mfma_f32_16x16x32_bf16 v[80:83], a[108:111], v[76:79], v[80:83]
  v_add_f32_dpp v4, v85, v84 quad_perm:[1,1,1,1] row_mask:0xf bank_mask:0xf
  v_add_f32_dpp v5, v87, v86 quad_perm:[3,3,3,3] row_mask:0xf bank_mask:0xf
  s_nop 1
  v_add_f32_dpp v53, v5, v4 quad_perm:[2,2,2,2] row_mask:0xf bank_mask:0xf
  v_cvt_pk_bf16_f32 v53, v53, v53
  v_and_b32 v53, 0xffff0000, v53
  v_mul_f32 v53, 0x3db504f3, v53
  v_cvt_pk_bf16_f32 v53, v53, v53
  v_and_b32 v53, 0xffff0000, v53
  v_max_f32 v20, v20, v53
  v_mfma_f32_16x16x32_bf16 v[84:87], a[112:115], v[64:67], 0
  v_mfma_f32_16x16x32_bf16 v[84:87], a[116:119], v[68:71], v[84:87]
  s_waitcnt vmcnt(11)
  s_mov_b32 s76, 249856
  buffer_load_dwordx4 a[244:247], v8, s[28:31], s76 offen offset:0 nt
  v_mfma_f32_16x16x32_bf16 v[84:87], a[120:123], v[72:75], v[84:87]
  v_mfma_f32_16x16x32_bf16 v[84:87], a[124:127], v[76:79], v[84:87]
  v_add_f32_dpp v4, v81, v80 quad_perm:[1,1,1,1] row_mask:0xf bank_mask:0xf
  v_add_f32_dpp v5, v83, v82 quad_perm:[3,3,3,3] row_mask:0xf bank_mask:0xf
  s_nop 1
  v_add_f32_dpp v54, v5, v4 quad_perm:[2,2,2,2] row_mask:0xf bank_mask:0xf
  v_cvt_pk_bf16_f32 v54, v54, v54
  v_and_b32 v54, 0xffff0000, v54
  v_mul_f32 v54, 0x3db504f3, v54
  v_cvt_pk_bf16_f32 v54, v54, v54
  v_and_b32 v54, 0xffff0000, v54
  v_max_f32 v20, v20, v54
  v_mfma_f32_16x16x32_bf16 v[80:83], a[128:131], v[64:67], 0
  v_mfma_f32_16x16x32_bf16 v[80:83], a[132:135], v[68:71], v[80:83]
  v_mfma_f32_16x16x32_bf16 v[80:83], a[136:139], v[72:75], v[80:83]
  v_mfma_f32_16x16x32_bf16 v[80:83], a[140:143], v[76:79], v[80:83]
  v_add_f32_dpp v4, v85, v84 quad_perm:[1,1,1,1] row_mask:0xf bank_mask:0xf
  v_add_f32_dpp v5, v87, v86 quad_perm:[3,3,3,3] row_mask:0xf bank_mask:0xf
  s_nop 1
  v_add_f32_dpp v55, v5, v4 quad_perm:[2,2,2,2] row_mask:0xf bank_mask:0xf
  v_cvt_pk_bf16_f32 v55, v55, v55
  v_and_b32 v55, 0xffff0000, v55
  v_mul_f32 v55, 0x3db504f3, v55
  v_cvt_pk_bf16_f32 v55, v55, v55
  v_and_b32 v55, 0xffff0000, v55
  v_max_f32 v20, v20, v55
  s_waitcnt vmcnt(11)
  s_mov_b32 s76, 253952
  buffer_load_dwordx4 a[248:251], v8, s[28:31], s76 offen offset:0 nt
  v_mfma_f32_16x16x32_bf16 v[84:87], a[144:147], v[64:67], 0
  v_mfma_f32_16x16x32_bf16 v[84:87], a[148:151], v[68:71], v[84:87]
  v_mfma_f32_16x16x32_bf16 v[84:87], a[152:155], v[72:75], v[84:87]
  v_mfma_f32_16x16x32_bf16 v[84:87], a[156:159], v[76:79], v[84:87]
  v_add_f32_dpp v4, v81, v80 quad_perm:[1,1,1,1] row_mask:0xf bank_mask:0xf
  v_add_f32_dpp v5, v83, v82 quad_perm:[3,3,3,3] row_mask:0xf bank_mask:0xf
  s_nop 1
  v_add_f32_dpp v56, v5, v4 quad_perm:[2,2,2,2] row_mask:0xf bank_mask:0xf
  v_cvt_pk_bf16_f32 v56, v56, v56
  v_and_b32 v56, 0xffff0000, v56
  v_mul_f32 v56, 0x3db504f3, v56
  v_cvt_pk_bf16_f32 v56, v56, v56
  v_and_b32 v56, 0xffff0000, v56
  v_max_f32 v20, v20, v56
  v_mfma_f32_16x16x32_bf16 v[80:83], a[160:163], v[64:67], 0
  v_mfma_f32_16x16x32_bf16 v[80:83], a[164:167], v[68:71], v[80:83]
  s_waitcnt vmcnt(11)
  s_mov_b32 s76, 258048
  buffer_load_dwordx4 a[252:255], v8, s[28:31], s76 offen offset:0 nt
  v_mfma_f32_16x16x32_bf16 v[80:83], a[168:171], v[72:75], v[80:83]
  v_mfma_f32_16x16x32_bf16 v[80:83], a[172:175], v[76:79], v[80:83]
  v_add_f32_dpp v4, v85, v84 quad_perm:[1,1,1,1] row_mask:0xf bank_mask:0xf
  v_add_f32_dpp v5, v87, v86 quad_perm:[3,3,3,3] row_mask:0xf bank_mask:0xf
  s_nop 1
  v_add_f32_dpp v57, v5, v4 quad_perm:[2,2,2,2] row_mask:0xf bank_mask:0xf
  v_cvt_pk_bf16_f32 v57, v57, v57
  v_and_b32 v57, 0xffff0000, v57
  v_mul_f32 v57, 0x3db504f3, v57
  v_cvt_pk_bf16_f32 v57, v57, v57
  v_and_b32 v57, 0xffff0000, v57
  v_max_f32 v20, v20, v57
  v_mfma_f32_16x16x32_bf16 v[84:87], a[176:179], v[64:67], 0
  v_mfma_f32_16x16x32_bf16 v[84:87], a[180:183], v[68:71], v[84:87]
  v_mfma_f32_16x16x32_bf16 v[84:87], a[184:187], v[72:75], v[84:87]
  v_mfma_f32_16x16x32_bf16 v[84:87], a[188:191], v[76:79], v[84:87]
  v_add_f32_dpp v4, v81, v80 quad_perm:[1,1,1,1] row_mask:0xf bank_mask:0xf
  v_add_f32_dpp v5, v83, v82 quad_perm:[3,3,3,3] row_mask:0xf bank_mask:0xf
  s_nop 1
  v_add_f32_dpp v58, v5, v4 quad_perm:[2,2,2,2] row_mask:0xf bank_mask:0xf
  v_cvt_pk_bf16_f32 v58, v58, v58
  v_and_b32 v58, 0xffff0000, v58
  v_mul_f32 v58, 0x3db504f3, v58
  v_cvt_pk_bf16_f32 v58, v58, v58
  v_and_b32 v58, 0xffff0000, v58
  v_max_f32 v20, v20, v58
  s_waitcnt vmcnt(11)
  s_mov_b32 s76, 0
  buffer_load_dwordx4 v[164:167], v9, s[32:35], s76 offen offset:0 nt
  v_mfma_f32_16x16x32_bf16 v[80:83], a[192:195], v[64:67], 0
  v_mfma_f32_16x16x32_bf16 v[80:83], a[196:199], v[68:71], v[80:83]
  v_mfma_f32_16x16x32_bf16 v[80:83], a[200:203], v[72:75], v[80:83]
  v_mfma_f32_16x16x32_bf16 v[80:83], a[204:207], v[76:79], v[80:83]
  v_add_f32_dpp v4, v85, v84 quad_perm:[1,1,1,1] row_mask:0xf bank_mask:0xf
  v_add_f32_dpp v5, v87, v86 quad_perm:[3,3,3,3] row_mask:0xf bank_mask:0xf
  s_nop 1
  v_add_f32_dpp v59, v5, v4 quad_perm:[2,2,2,2] row_mask:0xf bank_mask:0xf
  v_cvt_pk_bf16_f32 v59, v59, v59
  v_and_b32 v59, 0xffff0000, v59
  v_mul_f32 v59, 0x3db504f3, v59
  v_cvt_pk_bf16_f32 v59, v59, v59
  v_and_b32 v59, 0xffff0000, v59
  v_max_f32 v20, v20, v59
  v_mfma_f32_16x16x32_bf16 v[84:87], a[208:211], v[64:67], 0
  s_waitcnt vmcnt(11)
  s_mov_b32 s76, 4096
  buffer_load_dwordx4 v[168:171], v9, s[32:35], s76 offen offset:0 nt
  v_mfma_f32_16x16x32_bf16 v[84:87], a[212:215], v[68:71], v[84:87]
  s_waitcnt vmcnt(11)
  s_mov_b32 s76, 8192
  buffer_load_dwordx4 v[172:175], v9, s[32:35], s76 offen offset:0 nt
  v_mfma_f32_16x16x32_bf16 v[84:87], a[216:219], v[72:75], v[84:87]
  s_waitcnt vmcnt(11)
  s_mov_b32 s76, 12288
  buffer_load_dwordx4 v[176:179], v9, s[32:35], s76 offen offset:0 nt
  v_mfma_f32_16x16x32_bf16 v[84:87], a[220:223], v[76:79], v[84:87]
  v_add_f32_dpp v4, v81, v80 quad_perm:[1,1,1,1] row_mask:0xf bank_mask:0xf
  v_add_f32_dpp v5, v83, v82 quad_perm:[3,3,3,3] row_mask:0xf bank_mask:0xf
  s_nop 1
  v_add_f32_dpp v60, v5, v4 quad_perm:[2,2,2,2] row_mask:0xf bank_mask:0xf
  v_cvt_pk_bf16_f32 v60, v60, v60
  v_and_b32 v60, 0xffff0000, v60
  v_mul_f32 v60, 0x3db504f3, v60
  v_cvt_pk_bf16_f32 v60, v60, v60
  v_and_b32 v60, 0xffff0000, v60
  v_max_f32 v20, v20, v60
  s_waitcnt vmcnt(11)
  s_mov_b32 s76, 16384
  buffer_load_dwordx4 v[180:183], v9, s[32:35], s76 offen offset:0 nt
  v_mfma_f32_16x16x32_bf16 v[80:83], a[224:227], v[64:67], 0
  s_waitcnt vmcnt(11)
  s_mov_b32 s76, 20480
  buffer_load_dwordx4 v[184:187], v9, s[32:35], s76 offen offset:0 nt
  v_mfma_f32_16x16x32_bf16 v[80:83], a[228:231], v[68:71], v[80:83]
  s_waitcnt vmcnt(11)
  s_mov_b32 s76, 24576
  buffer_load_dwordx4 v[188:191], v9, s[32:35], s76 offen offset:0 nt
  v_mfma_f32_16x16x32_bf16 v[80:83], a[232:235], v[72:75], v[80:83]
  s_waitcnt vmcnt(11)
  s_mov_b32 s76, 28672
  buffer_load_dwordx4 v[192:195], v9, s[32:35], s76 offen offset:0 nt
  v_mfma_f32_16x16x32_bf16 v[80:83], a[236:239], v[76:79], v[80:83]
  v_add_f32_dpp v4, v85, v84 quad_perm:[1,1,1,1] row_mask:0xf bank_mask:0xf
  v_add_f32_dpp v5, v87, v86 quad_perm:[3,3,3,3] row_mask:0xf bank_mask:0xf
  s_nop 1
  v_add_f32_dpp v61, v5, v4 quad_perm:[2,2,2,2] row_mask:0xf bank_mask:0xf
  v_cvt_pk_bf16_f32 v61, v61, v61
  v_and_b32 v61, 0xffff0000, v61
  v_mul_f32 v61, 0x3db504f3, v61
  v_cvt_pk_bf16_f32 v61, v61, v61
  v_and_b32 v61, 0xffff0000, v61
  v_max_f32 v20, v20, v61
  s_waitcnt vmcnt(11)
  s_mov_b32 s76, 32768
  buffer_load_dwordx4 v[196:199], v9, s[32:35], s76 offen offset:0 nt
  v_mfma_f32_16x16x32_bf16 v[84:87], a[240:243], v[64:67], 0
  s_waitcnt vmcnt(11)
  s_mov_b32 s76, 36864
  buffer_load_dwordx4 v[200:203], v9, s[32:35], s76 offen offset:0 nt
  v_mfma_f32_16x16x32_bf16 v[84:87], a[244:247], v[68:71], v[84:87]
  s_waitcnt vmcnt(11)
  s_mov_b32 s76, 40960
  buffer_load_dwordx4 v[204:207], v9, s[32:35], s76 offen offset:0 nt
  v_mfma_f32_16x16x32_bf16 v[84:87], a[248:251], v[72:75], v[84:87]
  s_waitcnt vmcnt(11)
  s_mov_b32 s76, 45056
  buffer_load_dwordx4 v[208:211], v9, s[32:35], s76 offen offset:0 nt
  v_mfma_f32_16x16x32_bf16 v[84:87], a[252:255], v[76:79], v[84:87]
  v_add_f32_dpp v4, v81, v80 quad_perm:[1,1,1,1] row_mask:0xf bank_mask:0xf
  v_add_f32_dpp v5, v83, v82 quad_perm:[3,3,3,3] row_mask:0xf bank_mask:0xf
  s_nop 1
  v_add_f32_dpp v62, v5, v4 quad_perm:[2,2,2,2] row_mask:0xf bank_mask:0xf
  v_cvt_pk_bf16_f32 v62, v62, v62
  v_and_b32 v62, 0xffff0000, v62
  v_mul_f32 v62, 0x3db504f3, v62
  v_cvt_pk_bf16_f32 v62, v62, v62
  v_and_b32 v62, 0xffff0000, v62
  v_max_f32 v20, v20, v62
  v_add_f32_dpp v4, v85, v84 quad_perm:[1,1,1,1] row_mask:0xf bank_mask:0xf
  v_add_f32_dpp v5, v87, v86 quad_perm:[3,3,3,3] row_mask:0xf bank_mask:0xf
  s_nop 1
  v_add_f32_dpp v63, v5, v4 quad_perm:[2,2,2,2] row_mask:0xf bank_mask:0xf
  v_cvt_pk_bf16_f32 v63, v63, v63
  v_and_b32 v63, 0xffff0000, v63
  v_mul_f32 v63, 0x3db504f3, v63
  v_cvt_pk_bf16_f32 v63, v63, v63
  v_and_b32 v63, 0xffff0000, v63
  v_max_f32 v20, v20, v63
  s_nop 1
  v_max_f32_dpp v20, v20, v20 row_ror:8 row_mask:0xf bank_mask:0xf
  s_nop 1
  v_max_f32_dpp v20, v20, v20 row_ror:4 row_mask:0xf bank_mask:0xf
  v_mov_b32 v5, v20
  s_nop 1
  v_permlane16_swap_b32 v5, v20
  v_max_f32 v20, v5, v20
  v_mov_b32 v5, v20
  s_nop 1
  v_permlane32_swap_b32 v5, v20
  v_max_f32 v20, v5, v20
  s_nop 1
  v_mov_b32_dpp v36, v20 quad_perm:[0,0,0,0] row_mask:0xf bank_mask:0xf
  v_mul_f32 v6, 0xbfb8aa3b, v36
  s_mov_b32 s75, 0x3fb8aa3b
  v_mov_b32 v21, 0
  v_fma_f32 v48, v48, s75, v6
  v_exp_f32 v48, v48
  v_fma_f32 v49, v49, s75, v6
  v_exp_f32 v49, v49
  v_fma_f32 v50, v50, s75, v6
  v_exp_f32 v50, v50
  v_fma_f32 v51, v51, s75, v6
  v_exp_f32 v51, v51
  s_waitcnt vmcnt(11)
  s_mov_b32 s76, 49152
  buffer_load_dwordx4 v[212:215], v9, s[32:35], s76 offen offset:0 nt
  v_fma_f32 v52, v52, s75, v6
  v_exp_f32 v52, v52
  v_fma_f32 v53, v53, s75, v6
  v_exp_f32 v53, v53
  v_fma_f32 v54, v54, s75, v6
  v_exp_f32 v54, v54
  v_fma_f32 v55, v55, s75, v6
  v_exp_f32 v55, v55
  s_waitcnt vmcnt(11)
  s_mov_b32 s76, 53248
  buffer_load_dwordx4 v[216:219], v9, s[32:35], s76 offen offset:0 nt
  v_fma_f32 v56, v56, s75, v6
  v_exp_f32 v56, v56
  v_fma_f32 v57, v57, s75, v6
  v_exp_f32 v57, v57
  v_fma_f32 v58, v58, s75, v6
  v_exp_f32 v58, v58
  v_fma_f32 v59, v59, s75, v6
  v_exp_f32 v59, v59
  s_waitcnt vmcnt(11)
  s_mov_b32 s76, 57344
  buffer_load_dwordx4 v[220:223], v9, s[32:35], s76 offen offset:0 nt
  v_fma_f32 v60, v60, s75, v6
  v_exp_f32 v60, v60
  v_fma_f32 v61, v61, s75, v6
  v_exp_f32 v61, v61
  v_fma_f32 v62, v62, s75, v6
  v_exp_f32 v62, v62
  v_fma_f32 v63, v63, s75, v6
  v_exp_f32 v63, v63
  s_waitcnt vmcnt(11)
  s_mov_b32 s76, 61440
  buffer_load_dwordx4 v[224:227], v9, s[32:35], s76 offen offset:0 nt
  v_add_f32 v21, v21, v48
  v_cvt_pk_bf16_f32 v48, v48, v48
  v_add_f32 v21, v21, v49
  v_cvt_pk_bf16_f32 v49, v49, v49
  v_add_f32 v21, v21, v50
  v_cvt_pk_bf16_f32 v50, v50, v50
  v_add_f32 v21, v21, v51
  v_cvt_pk_bf16_f32 v51, v51, v51
  v_add_f32 v21, v21, v52
  v_cvt_pk_bf16_f32 v52, v52, v52
  v_add_f32 v21, v21, v53
  v_cvt_pk_bf16_f32 v53, v53, v53
  v_add_f32 v21, v21, v54
  v_cvt_pk_bf16_f32 v54, v54, v54
  v_add_f32 v21, v21, v55
  v_cvt_pk_bf16_f32 v55, v55, v55
  v_add_f32 v21, v21, v56
  v_cvt_pk_bf16_f32 v56, v56, v56
  v_add_f32 v21, v21, v57
  v_cvt_pk_bf16_f32 v57, v57, v57
  v_add_f32 v21, v21, v58
  v_cvt_pk_bf16_f32 v58, v58, v58
  v_add_f32 v21, v21, v59
  v_cvt_pk_bf16_f32 v59, v59, v59
  v_add_f32 v21, v21, v60
  v_cvt_pk_bf16_f32 v60, v60, v60
  v_add_f32 v21, v21, v61
  v_cvt_pk_bf16_f32 v61, v61, v61
  v_add_f32 v21, v21, v62
  v_cvt_pk_bf16_f32 v62, v62, v62
  v_add_f32 v21, v21, v63
  v_cvt_pk_bf16_f32 v63, v63, v63
  s_nop 0
  v_add_f32_dpp v21, v21, v21 row_ror:8 row_mask:0xf bank_mask:0xf
  s_nop 1
  v_add_f32_dpp v21, v21, v21 row_ror:4 row_mask:0xf bank_mask:0xf
  v_mov_b32 v5, v21
  s_nop 1
  v_permlane16_swap_b32 v5, v21
  v_add_f32 v21, v5, v21
  v_mov_b32 v5, v21
  s_nop 1
  v_permlane32_swap_b32 v5, v21
  v_add_f32 v21, v5, v21
  v_mov_b32 v37, v21
  s_mov_b64 exec, 0x11
  ds_write_b128 v26, v[36:39] offset:0
  s_mov_b64 exec, -1
  s_waitcnt vmcnt(11)
  s_mov_b32 s76, 65536
  buffer_load_dwordx4 a[0:3], v9, s[32:35], s76 offen offset:0 nt
  v_and_b32_dpp v100, v48, v44 row_newbcast:0 row_mask:0xf bank_mask:0xf
  v_and_b32_dpp v101, v48, v45 row_newbcast:0 row_mask:0xf bank_mask:0xf
  v_and_b32_dpp v102, v48, v46 row_newbcast:0 row_mask:0xf bank_mask:0xf
  v_and_b32_dpp v103, v48, v47 row_newbcast:0 row_mask:0xf bank_mask:0xf
  s_nop 1
  v_mfma_f32_16x16x32_bf16 v[88:91], v[100:103], v[164:167], 0
  v_and_b32_dpp v104, v48, v44 row_newbcast:4 row_mask:0xf bank_mask:0xf
  v_and_b32_dpp v105, v48, v45 row_newbcast:4 row_mask:0xf bank_mask:0xf
  v_and_b32_dpp v106, v48, v46 row_newbcast:4 row_mask:0xf bank_mask:0xf
  v_and_b32_dpp v107, v48, v47 row_newbcast:4 row_mask:0xf bank_mask:0xf
  s_nop 1
  v_mfma_f32_16x16x32_bf16 v[88:91], v[104:107], v[168:171], v[88:91]
  v_and_b32_dpp v100, v48, v44 row_newbcast:8 row_mask:0xf bank_mask:0xf
  v_and_b32_dpp v101, v48, v45 row_newbcast:8 row_mask:0xf bank_mask:0xf
  v_and_b32_dpp v102, v48, v46 row_newbcast:8 row_mask:0xf bank_mask:0xf
  v_and_b32_dpp v103, v48, v47 row_newbcast:8 row_mask:0xf bank_mask:0xf
  s_nop 1
  v_mfma_f32_16x16x32_bf16 v[88:91], v[100:103], v[172:175], v[88:91]
  v_and_b32_dpp v104, v48, v44 row_newbcast:12 row_mask:0xf bank_mask:0xf
  v_and_b32_dpp v105, v48, v45 row_newbcast:12 row_mask:0xf bank_mask:0xf
  v_and_b32_dpp v106, v48, v46 row_newbcast:12 row_mask:0xf bank_mask:0xf
  v_and_b32_dpp v107, v48, v47 row_newbcast:12 row_mask:0xf bank_mask:0xf
  s_nop 1
  v_mfma_f32_16x16x32_bf16 v[88:91], v[104:107], v[176:179], v[88:91]
  v_and_b32_dpp v100, v49, v44 row_newbcast:0 row_mask:0xf bank_mask:0xf
  v_and_b32_dpp v101, v49, v45 row_newbcast:0 row_mask:0xf bank_mask:0xf
  v_and_b32_dpp v102, v49, v46 row_newbcast:0 row_mask:0xf bank_mask:0xf
  v_and_b32_dpp v103, v49, v47 row_newbcast:0 row_mask:0xf bank_mask:0xf
  s_nop 1
  v_mfma_f32_16x16x32_bf16 v[88:91], v[100:103], v[180:183], v[88:91]
  v_and_b32_dpp v104, v49, v44 row_newbcast:4 row_mask:0xf bank_mask:0xf
  v_and_b32_dpp v105, v49, v45 row_newbcast:4 row_mask:0xf bank_mask:0xf
  v_and_b32_dpp v106, v49, v46 row_newbcast:4 row_mask:0xf bank_mask:0xf
  v_and_b32_dpp v107, v49, v47 row_newbcast:4 row_mask:0xf bank_mask:0xf
  s_waitcnt vmcnt(11)
  s_mov_b32 s76, 69632
  buffer_load_dwordx4 a[4:7], v9, s[32:35], s76 offen offset:0 nt
  v_mfma_f32_16x16x32_bf16 v[88:91], v[104:107], v[184:187], v[88:91]
  v_and_b32_dpp v100, v49, v44 row_newbcast:8 row_mask:0xf bank_mask:0xf
  v_and_b32_dpp v101, v49, v45 row_newbcast:8 row_mask:0xf bank_mask:0xf
  v_and_b32_dpp v102, v49, v46 row_newbcast:8 row_mask:0xf bank_mask:0xf
  v_and_b32_dpp v103, v49, v47 row_newbcast:8 row_mask:0xf bank_mask:0xf
  s_waitcnt vmcnt(11)
  s_mov_b32 s76, 73728
  buffer_load_dwordx4 a[8:11], v9, s[32:35], s76 offen offset:0 nt
  v_mfma_f32_16x16x32_bf16 v[88:91], v[100:103], v[188:191], v[88:91]
  v_and_b32_dpp v104, v49, v44 row_newbcast:12 row_mask:0xf bank_mask:0xf
  v_and_b32_dpp v105, v49, v45 row_newbcast:12 row_mask:0xf bank_mask:0xf
  v_and_b32_dpp v106, v49, v46 row_newbcast:12 row_mask:0xf bank_mask:0xf
  v_and_b32_dpp v107, v49, v47 row_newbcast:12 row_mask:0xf bank_mask:0xf
  s_waitcnt lgkmcnt(0)
  s_barrier
  s_cmp_lg_u32 s64, 0
  s_cbranch_scc1 L_nostat
  s_mov_b64 exec, 0xff
  ds_read_b128 v[40:43], v9 offset:0
  s_waitcnt lgkmcnt(0)
  s_cmp_eq_u32 s89, 0
  s_cbranch_scc1 L_fars
  buffer_store_dwordx4 v[40:43], v9, s[48:51], s83 offen
  s_branch L_sts
L_fars:
  buffer_store_dwordx4 v[40:43], v9, s[48:51], s83 offen sc0 sc1
L_sts:
  s_mov_b64 exec, -1
L_nostat:
  s_waitcnt vmcnt(11)
  s_mov_b32 s76, 77824
  buffer_load_dwordx4 a[12:15], v9, s[32:35], s76 offen offset:0 nt
  v_mfma_f32_16x16x32_bf16 v[88:91], v[104:107], v[192:195], v[88:91]
  v_and_b32_dpp v100, v50, v44 row_newbcast:0 row_mask:0xf bank_mask:0xf
  v_and_b32_dpp v101, v50, v45 row_newbcast:0 row_mask:0xf bank_mask:0xf
  v_and_b32_dpp v102, v50, v46 row_newbcast:0 row_mask:0xf bank_mask:0xf
  v_and_b32_dpp v103, v50, v47 row_newbcast:0 row_mask:0xf bank_mask:0xf
  s_waitcnt vmcnt(11)
  s_mov_b32 s76, 81920
  buffer_load_dwordx4 a[16:19], v9, s[32:35], s76 offen offset:0 nt
  v_mfma_f32_16x16x32_bf16 v[88:91], v[100:103], v[196:199], v[88:91]
  v_and_b32_dpp v104, v50, v44 row_newbcast:4 row_mask:0xf bank_mask:0xf
  v_and_b32_dpp v105, v50, v45 row_newbcast:4 row_mask:0xf bank_mask:0xf
  v_and_b32_dpp v106, v50, v46 row_newbcast:4 row_mask:0xf bank_mask:0xf
  v_and_b32_dpp v107, v50, v47 row_newbcast:4 row_mask:0xf bank_mask:0xf
  s_waitcnt vmcnt(11)
  s_mov_b32 s76, 86016
  buffer_load_dwordx4 a[20:23], v9, s[32:35], s76 offen offset:0 nt
  v_mfma_f32_16x16x32_bf16 v[88:91], v[104:107], v[200:203], v[88:91]
  v_and_b32_dpp v100, v50, v44 row_newbcast:8 row_mask:0xf bank_mask:0xf
  v_and_b32_dpp v101, v50, v45 row_newbcast:8 row_mask:0xf bank_mask:0xf
  v_and_b32_dpp v102, v50, v46 row_newbcast:8 row_mask:0xf bank_mask:0xf
  v_and_b32_dpp v103, v50, v47 row_newbcast:8 row_mask:0xf bank_mask:0xf
  s_waitcnt vmcnt(11)
  s_mov_b32 s76, 90112
  buffer_load_dwordx4 a[24:27], v9, s[32:35], s76 offen offset:0 nt
  v_mfma_f32_16x16x32_bf16 v[88:91], v[100:103], v[204:207], v[88:91]
  v_and_b32_dpp v104, v50, v44 row_newbcast:12 row_mask:0xf bank_mask:0xf
  v_and_b32_dpp v105, v50, v45 row_newbcast:12 row_mask:0xf bank_mask:0xf
  v_and_b32_dpp v106, v50, v46 row_newbcast:12 row_mask:0xf bank_mask:0xf
  v_and_b32_dpp v107, v50, v47 row_newbcast:12 row_mask:0xf bank_mask:0xf
  s_waitcnt vmcnt(11)
  s_mov_b32 s76, 94208
  buffer_load_dwordx4 a[28:31], v9, s[32:35], s76 offen offset:0 nt
  v_lshrrev_b32 v4, 3, v1
  v_and_b32 v5, 7, v1
  v_lshlrev_b32 v5, 4, v5
  v_lshl_add_u32 v4, v4, 11, v5
  buffer_load_dwordx4 v[132:135], v4, s[48:51], s80 offen offset:512 sc1
  buffer_load_dwordx4 v[136:139], v4, s[48:51], s80 offen offset:1024 sc1
  v_and_b32 v4, 7, v3
  v_lshlrev_b32 v4, 11, v4
  v_lshrrev_b32 v5, 3, v3
  v_lshl_add_u32 v4, v5, 6, v4
  v_lshl_add_u32 v4, v2, 2, v4
  s_lshl_b32 s72, s62, 14
  s_lshl_b32 s73, s64, 4
  s_add_u32 s72, s72, s73
  buffer_load_dword v140, v4, s[48:51], s72 offen offset:1536 sc1
  buffer_load_ushort v23, v16, s[36:39], s85 offen
  v_mfma_f32_16x16x32_bf16 v[88:91], v[104:107], v[208:211], v[88:91]
  v_and_b32_dpp v100, v51, v44 row_newbcast:0 row_mask:0xf bank_mask:0xf
  v_and_b32_dpp v101, v51, v45 row_newbcast:0 row_mask:0xf bank_mask:0xf
  v_and_b32_dpp v102, v51, v46 row_newbcast:0 row_mask:0xf bank_mask:0xf
  v_and_b32_dpp v103, v51, v47 row_newbcast:0 row_mask:0xf bank_mask:0xf
  s_waitcnt vmcnt(11)
  s_lshl_b32 s72, s62, 7
  s_lshl_b32 s73, s64, 5
  s_addk_i32 s73, 0
  s_add_u32 s72, s72, s73
  s_mul_i32 s72, s72, 1152
  buffer_load_dwordx4 a[192:195], v10, s[44:47], s72 offen nt
  v_mfma_f32_16x16x32_bf16 v[88:91], v[100:103], v[212:215], v[88:91]
  v_and_b32_dpp v104, v51, v44 row_newbcast:4 row_mask:0xf bank_mask:0xf
  v_and_b32_dpp v105, v51, v45 row_newbcast:4 row_mask:0xf bank_mask:0xf
  v_and_b32_dpp v106, v51, v46 row_newbcast:4 row_mask:0xf bank_mask:0xf
  v_and_b32_dpp v107, v51, v47 row_newbcast:4 row_mask:0xf bank_mask:0xf
  s_nop 1
  v_mfma_f32_16x16x32_bf16 v[88:91], v[104:107], v[216:219], v[88:91]
  v_and_b32_dpp v100, v51, v44 row_newbcast:8 row_mask:0xf bank_mask:0xf
  v_and_b32_dpp v101, v51, v45 row_newbcast:8 row_mask:0xf bank_mask:0xf
  v_and_b32_dpp v102, v51, v46 row_newbcast:8 row_mask:0xf bank_mask:0xf
  v_and_b32_dpp v103, v51, v47 row_newbcast:8 row_mask:0xf bank_mask:0xf
  s_nop 1
  v_mfma_f32_16x16x32_bf16 v[88:91], v[100:103], v[220:223], v[88:91]
  v_and_b32_dpp v104, v51, v44 row_newbcast:12 row_mask:0xf bank_mask:0xf
  v_and_b32_dpp v105, v51, v45 row_newbcast:12 row_mask:0xf bank_mask:0xf
  v_and_b32_dpp v106, v51, v46 row_newbcast:12 row_mask:0xf bank_mask:0xf
  v_and_b32_dpp v107, v51, v47 row_newbcast:12 row_mask:0xf bank_mask:0xf
  s_nop 1
  v_mfma_f32_16x16x32_bf16 v[88:91], v[104:107], v[224:227], v[88:91]
  v_and_b32_dpp v100, v52, v44 row_newbcast:0 row_mask:0xf bank_mask:0xf
  v_and_b32_dpp v101, v52, v45 row_newbcast:0 row_mask:0xf bank_mask:0xf
  v_and_b32_dpp v102, v52, v46 row_newbcast:0 row_mask:0xf bank_mask:0xf
  v_and_b32_dpp v103, v52, v47 row_newbcast:0 row_mask:0xf bank_mask:0xf
  s_nop 1
  v_mfma_f32_16x16x32_bf16 v[88:91], v[100:103], a[0:3], v[88:91]
  v_and_b32_dpp v104, v52, v44 row_newbcast:4 row_mask:0xf bank_mask:0xf
  v_and_b32_dpp v105, v52, v45 row_newbcast:4 row_mask:0xf bank_mask:0xf
  v_and_b32_dpp v106, v52, v46 row_newbcast:4 row_mask:0xf bank_mask:0xf
  v_and_b32_dpp v107, v52, v47 row_newbcast:4 row_mask:0xf bank_mask:0xf
  s_waitcnt vmcnt(11)
  s_lshl_b32 s72, s62, 7
  s_lshl_b32 s73, s64, 5
  s_addk_i32 s73, 4
  s_add_u32 s72, s72, s73
  s_mul_i32 s72, s72, 1152
  buffer_load_dwordx4 a[196:199], v10, s[44:47], s72 offen nt
  v_mfma_f32_16x16x32_bf16 v[88:91], v[104:107], a[4:7], v[88:91]
  v_and_b32_dpp v100, v52, v44 row_newbcast:8 row_mask:0xf bank_mask:0xf
  v_and_b32_dpp v101, v52, v45 row_newbcast:8 row_mask:0xf bank_mask:0xf
  v_and_b32_dpp v102, v52, v46 row_newbcast:8 row_mask:0xf bank_mask:0xf
  v_and_b32_dpp v103, v52, v47 row_newbcast:8 row_mask:0xf bank_mask:0xf
  s_waitcnt vmcnt(11)
  s_lshl_b32 s72, s62, 7
  s_lshl_b32 s73, s64, 5
  s_addk_i32 s73, 8
  s_add_u32 s72, s72, s73
  s_mul_i32 s72, s72, 1152
  buffer_load_dwordx4 a[200:203], v10, s[44:47], s72 offen nt
  v_mfma_f32_16x16x32_bf16 v[88:91], v[100:103], a[8:11], v[88:91]
  v_and_b32_dpp v104, v52, v44 row_newbcast:12 row_mask:0xf bank_mask:0xf
  v_and_b32_dpp v105, v52, v45 row_newbcast:12 row_mask:0xf bank_mask:0xf
  v_and_b32_dpp v106, v52, v46 row_newbcast:12 row_mask:0xf bank_mask:0xf
  v_and_b32_dpp v107, v52, v47 row_newbcast:12 row_mask:0xf bank_mask:0xf
  s_waitcnt vmcnt(11)
  s_lshl_b32 s72, s62, 7
  s_lshl_b32 s73, s64, 5
  s_addk_i32 s73, 12
  s_add_u32 s72, s72, s73
  s_mul_i32 s72, s72, 1152
  buffer_load_dwordx4 a[204:207], v10, s[44:47], s72 offen nt
  v_mfma_f32_16x16x32_bf16 v[88:91], v[104:107], a[12:15], v[88:91]
  v_and_b32_dpp v100, v53, v44 row_newbcast:0 row_mask:0xf bank_mask:0xf
  v_and_b32_dpp v101, v53, v45 row_newbcast:0 row_mask:0xf bank_mask:0xf
  v_and_b32_dpp v102, v53, v46 row_newbcast:0 row_mask:0xf bank_mask:0xf
  v_and_b32_dpp v103, v53, v47 row_newbcast:0 row_mask:0xf bank_mask:0xf
  s_waitcnt vmcnt(11)
  s_lshl_b32 s72, s62, 7
  s_lshl_b32 s73, s64, 5
  s_addk_i32 s73, 16
  s_add_u32 s72, s72, s73
  s_mul_i32 s72, s72, 1152
  buffer_load_dwordx4 a[208:211], v10, s[44:47], s72 offen nt
  v_mfma_f32_16x16x32_bf16 v[88:91], v[100:103], a[16:19], v[88:91]
  v_and_b32_dpp v104, v53, v44 row_newbcast:4 row_mask:0xf bank_mask:0xf
  v_and_b32_dpp v105, v53, v45 row_newbcast:4 row_mask:0xf bank_mask:0xf
  v_and_b32_dpp v106, v53, v46 row_newbcast:4 row_mask:0xf bank_mask:0xf
  v_and_b32_dpp v107, v53, v47 row_newbcast:4 row_mask:0xf bank_mask:0xf
  s_waitcnt vmcnt(11)
  s_lshl_b32 s72, s62, 7
  s_lshl_b32 s73, s64, 5
  s_addk_i32 s73, 20
  s_add_u32 s72, s72, s73
  s_mul_i32 s72, s72, 1152
  buffer_load_dwordx4 a[212:215], v10, s[44:47], s72 offen nt
  v_mfma_f32_16x16x32_bf16 v[88:91], v[104:107], a[20:23], v[88:91]
  v_and_b32_dpp v100, v53, v44 row_newbcast:8 row_mask:0xf bank_mask:0xf
  v_and_b32_dpp v101, v53, v45 row_newbcast:8 row_mask:0xf bank_mask:0xf
  v_and_b32_dpp v102, v53, v46 row_newbcast:8 row_mask:0xf bank_mask:0xf
  v_and_b32_dpp v103, v53, v47 row_newbcast:8 row_mask:0xf bank_mask:0xf
  s_waitcnt vmcnt(11)
  s_lshl_b32 s72, s62, 7
  s_lshl_b32 s73, s64, 5
  s_addk_i32 s73, 24
  s_add_u32 s72, s72, s73
  s_mul_i32 s72, s72, 1152
  buffer_load_dwordx4 a[216:219], v10, s[44:47], s72 offen nt
  v_mfma_f32_16x16x32_bf16 v[88:91], v[100:103], a[24:27], v[88:91]
  v_and_b32_dpp v104, v53, v44 row_newbcast:12 row_mask:0xf bank_mask:0xf
  v_and_b32_dpp v105, v53, v45 row_newbcast:12 row_mask:0xf bank_mask:0xf
  v_and_b32_dpp v106, v53, v46 row_newbcast:12 row_mask:0xf bank_mask:0xf
  v_and_b32_dpp v107, v53, v47 row_newbcast:12 row_mask:0xf bank_mask:0xf
  s_waitcnt vmcnt(11)
  s_lshl_b32 s72, s62, 7
  s_lshl_b32 s73, s64, 5
  s_addk_i32 s73, 28
  s_add_u32 s72, s72, s73
  s_mul_i32 s72, s72, 1152
  buffer_load_dwordx4 a[220:223], v10, s[44:47], s72 offen nt
  v_mfma_f32_16x16x32_bf16 v[88:91], v[104:107], a[28:31], v[88:91]
  v_and_b32_dpp v100, v54, v44 row_newbcast:0 row_mask:0xf bank_mask:0xf
  v_and_b32_dpp v101, v54, v45 row_newbcast:0 row_mask:0xf bank_mask:0xf
  v_and_b32_dpp v102, v54, v46 row_newbcast:0 row_mask:0xf bank_mask:0xf
  v_and_b32_dpp v103, v54, v47 row_newbcast:0 row_mask:0xf bank_mask:0xf
  s_waitcnt vmcnt(11)
  s_lshl_b32 s72, s62, 4
  s_lshl_b32 s73, s64, 2
  s_addk_i32 s73, 4096
  s_add_u32 s72, s72, s73
  s_mul_i32 s72, s72, 1152
  buffer_load_dwordx4 a[224:227], v10, s[44:47], s72 offen nt
  s_waitcnt vmcnt(11)
  s_mov_b32 s76, 98304
  buffer_load_dwordx4 a[32:35], v9, s[32:35], s76 offen offset:0 nt
  s_waitcnt vmcnt(11)
  s_mov_b32 s76, 102400
  buffer_load_dwordx4 a[36:39], v9, s[32:35], s76 offen offset:0 nt
  v_permlane32_swap_b32 v132, v134
  v_permlane32_swap_b32 v133, v135
  v_add_f32 v132, v132, v134
  v_add_f32 v133, v133, v135
  s_nop 1
  v_permlane16_swap_b32 v132, v133
  v_add_f32 v132, v132, v133
  s_nop 1
  v_add_f32_dpp v132, v132, v132 row_ror:8 row_mask:0xf bank_mask:0xf
  v_cvt_pk_bf16_f32 v132, v132, v132
  v_and_b32 v132, 0xffff0000, v132
  v_permlane32_swap_b32 v136, v138
  v_permlane32_swap_b32 v137, v139
  v_add_f32 v136, v136, v138
  v_add_f32 v137, v137, v139
  s_nop 1
  v_permlane16_swap_b32 v136, v137
  v_add_f32 v136, v136, v137
  s_nop 1
  v_add_f32_dpp v136, v136, v136 row_ror:8 row_mask:0xf bank_mask:0xf
  v_cvt_pk_bf16_f32 v136, v136, v136
  v_and_b32 v136, 0xffff0000, v136
  v_max_f32 v132, 0, v132
  v_mul_f32 v132, v132, v136
  v_cvt_pk_bf16_f32 v112, v132, v132
  v_add_f32_dpp v140, v140, v140 quad_perm:[1,0,3,2] row_mask:0xf bank_mask:0xf
  s_nop 1
  v_add_f32_dpp v140, v140, v140 quad_perm:[2,3,0,1] row_mask:0xf bank_mask:0xf
  s_nop 1
  v_add_f32_dpp v140, v140, v140 row_half_mirror row_mask:0xf bank_mask:0xf
  v_cvt_pk_bf16_f32 v140, v140, v140
  v_and_b32 v140, 0xffff0000, v140
  v_max_f32 v141, 0, v140
  s_nop 1
  v_mul_f32_dpp v140, v140, v141 row_ror:8 row_mask:0xf bank_mask:0xf
  v_cvt_pk_bf16_f32 v113, v140, v140
  s_waitcnt vmcnt(11)
  s_mov_b32 s76, 106496
  buffer_load_dwordx4 a[40:43], v9, s[32:35], s76 offen offset:0 nt
  s_waitcnt vmcnt(11)
  s_mov_b32 s76, 110592
  buffer_load_dwordx4 a[44:47], v9, s[32:35], s76 offen offset:0 nt
  s_waitcnt vmcnt(11)
  s_mov_b32 s76, 114688
  buffer_load_dwordx4 a[48:51], v9, s[32:35], s76 offen offset:0 nt
  s_waitcnt vmcnt(11)
  s_mov_b32 s76, 118784
  buffer_load_dwordx4 a[52:55], v9, s[32:35], s76 offen offset:0 nt
  s_waitcnt vmcnt(11)
  s_mov_b32 s76, 122880
  buffer_load_dwordx4 a[56:59], v9, s[32:35], s76 offen offset:0 nt
  s_waitcnt vmcnt(11)
  s_mov_b32 s76, 126976
  buffer_load_dwordx4 a[60:63], v9, s[32:35], s76 offen offset:0 nt
  s_waitcnt vmcnt(11)
  s_mov_b32 s76, 131072
  buffer_load_dwordx4 a[64:67], v9, s[32:35], s76 offen offset:0 nt
  s_waitcnt vmcnt(11)
  s_mov_b32 s76, 135168
  buffer_load_dwordx4 a[68:71], v9, s[32:35], s76 offen offset:0 nt
  s_waitcnt vmcnt(11)
  s_mov_b32 s76, 139264
  buffer_load_dwordx4 a[72:75], v9, s[32:35], s76 offen offset:0 nt
  s_waitcnt vmcnt(11)
  s_mov_b32 s76, 143360
  buffer_load_dwordx4 a[76:79], v9, s[32:35], s76 offen offset:0 nt
  v_and_b32_dpp v152, v112, v44 row_newbcast:0 row_mask:0xf bank_mask:0xf
  v_and_b32_dpp v153, v112, v45 row_newbcast:0 row_mask:0xf bank_mask:0xf
  v_and_b32_dpp v154, v112, v46 row_newbcast:0 row_mask:0xf bank_mask:0xf
  v_and_b32_dpp v155, v112, v47 row_newbcast:0 row_mask:0xf bank_mask:0xf
  s_nop 1
  v_mfma_f32_16x16x32_bf16 v[92:95], v[152:155], a[192:195], 0
  v_and_b32_dpp v156, v112, v44 row_newbcast:1 row_mask:0xf bank_mask:0xf
  v_and_b32_dpp v157, v112, v45 row_newbcast:1 row_mask:0xf bank_mask:0xf
  v_and_b32_dpp v158, v112, v46 row_newbcast:1 row_mask:0xf bank_mask:0xf
  v_and_b32_dpp v159, v112, v47 row_newbcast:1 row_mask:0xf bank_mask:0xf
  s_nop 1
  v_mfma_f32_16x16x32_bf16 v[92:95], v[156:159], a[196:199], v[92:95]
  v_and_b32_dpp v152, v112, v44 row_newbcast:2 row_mask:0xf bank_mask:0xf
  v_and_b32_dpp v153, v112, v45 row_newbcast:2 row_mask:0xf bank_mask:0xf
  v_and_b32_dpp v154, v112, v46 row_newbcast:2 row_mask:0xf bank_mask:0xf
  v_and_b32_dpp v155, v112, v47 row_newbcast:2 row_mask:0xf bank_mask:0xf
  s_nop 1
  v_mfma_f32_16x16x32_bf16 v[92:95], v[152:155], a[200:203], v[92:95]
  v_and_b32_dpp v156, v112, v44 row_newbcast:3 row_mask:0xf bank_mask:0xf
  v_and_b32_dpp v157, v112, v45 row_newbcast:3 row_mask:0xf bank_mask:0xf
  v_and_b32_dpp v158, v112, v46 row_newbcast:3 row_mask:0xf bank_mask:0xf
  v_and_b32_dpp v159, v112, v47 row_newbcast:3 row_mask:0xf bank_mask:0xf
  s_nop 1
  v_mfma_f32_16x16x32_bf16 v[92:95], v[156:159], a[204:207], v[92:95]
  v_and_b32_dpp v152, v112, v44 row_newbcast:4 row_mask:0xf bank_mask:0xf
  v_and_b32_dpp v153, v112, v45 row_newbcast:4 row_mask:0xf bank_mask:0xf
  v_and_b32_dpp v154, v112, v46 row_newbcast:4 row_mask:0xf bank_mask:0xf
  v_and_b32_dpp v155, v112, v47 row_newbcast:4 row_mask:0xf bank_mask:0xf
  s_nop 1
  v_mfma_f32_16x16x32_bf16 v[92:95], v[152:155], a[208:211], v[92:95]
  v_and_b32_dpp v156, v112, v44 row_newbcast:5 row_mask:0xf bank_mask:0xf
  v_and_b32_dpp v157, v112, v45 row_newbcast:5 row_mask:0xf bank_mask:0xf
  v_and_b32_dpp v158, v112, v46 row_newbcast:5 row_mask:0xf bank_mask:0xf
  v_and_b32_dpp v159, v112, v47 row_newbcast:5 row_mask:0xf bank_mask:0xf
  s_nop 1
  v_mfma_f32_16x16x32_bf16 v[92:95], v[156:159], a[212:215], v[92:95]
  v_and_b32_dpp v152, v112, v44 row_newbcast:6 row_mask:0xf bank_mask:0xf
  v_and_b32_dpp v153, v112, v45 row_newbcast:6 row_mask:0xf bank_mask:0xf
  v_and_b32_dpp v154, v112, v46 row_newbcast:6 row_mask:0xf bank_mask:0xf
  v_and_b32_dpp v155, v112, v47 row_newbcast:6 row_mask:0xf bank_mask:0xf
  s_nop 1
  v_mfma_f32_16x16x32_bf16 v[92:95], v[152:155], a[216:219], v[92:95]
  v_and_b32_dpp v156, v112, v44 row_newbcast:7 row_mask:0xf bank_mask:0xf
  v_and_b32_dpp v157, v112, v45 row_newbcast:7 row_mask:0xf bank_mask:0xf
  v_and_b32_dpp v158, v112, v46 row_newbcast:7 row_mask:0xf bank_mask:0xf
  v_and_b32_dpp v159, v112, v47 row_newbcast:7 row_mask:0xf bank_mask:0xf
  s_nop 1
  v_mfma_f32_16x16x32_bf16 v[92:95], v[156:159], a[220:223], v[92:95]
  v_and_b32_dpp v152, v113, v44 row_newbcast:0 row_mask:0xf bank_mask:0xf
  v_and_b32_dpp v153, v113, v45 row_newbcast:0 row_mask:0xf bank_mask:0xf
  v_and_b32_dpp v154, v113, v46 row_newbcast:0 row_mask:0xf bank_mask:0xf
  v_and_b32_dpp v155, v113, v47 row_newbcast:0 row_mask:0xf bank_mask:0xf
  s_nop 1
  v_mfma_f32_16x16x32_bf16 v[92:95], v[152:155], a[224:227], v[92:95]
  v_and_b32 v4, 31, v1
  v_lshlrev_b32 v31, 3, v4
  v_lshrrev_b32 v5, 2, v4
  v_and_b32 v4, 3, v4
  v_lshlrev_b32 v4, 4, v4
  v_lshl_add_u32 v30, v5, 7, v4
  buffer_load_dwordx3 v[40:42], v30, s[48:51], s84 offen sc1
  buffer_load_dword v43, v31, s[56:59], 0 offen sc1
  s_waitcnt vmcnt(11)
  s_mov_b32 s76, 147456
  buffer_load_dwordx4 a[80:83], v9, s[32:35], s76 offen offset:0 nt
  v_mfma_f32_16x16x32_bf16 v[88:91], v[100:103], a[32:35], v[88:91]
  v_and_b32_dpp v104, v54, v44 row_newbcast:4 row_mask:0xf bank_mask:0xf
  v_and_b32_dpp v105, v54, v45 row_newbcast:4 row_mask:0xf bank_mask:0xf
  v_and_b32_dpp v106, v54, v46 row_newbcast:4 row_mask:0xf bank_mask:0xf
  v_and_b32_dpp v107, v54, v47 row_newbcast:4 row_mask:0xf bank_mask:0xf
  s_nop 1
  v_mfma_f32_16x16x32_bf16 v[88:91], v[104:107], a[36:39], v[88:91]
  v_and_b32_dpp v100, v54, v44 row_newbcast:8 row_mask:0xf bank_mask:0xf
  v_and_b32_dpp v101, v54, v45 row_newbcast:8 row_mask:0xf bank_mask:0xf
  v_and_b32_dpp v102, v54, v46 row_newbcast:8 row_mask:0xf bank_mask:0xf
  v_and_b32_dpp v103, v54, v47 row_newbcast:8 row_mask:0xf bank_mask:0xf
  s_nop 1
  v_mfma_f32_16x16x32_bf16 v[88:91], v[100:103], a[40:43], v[88:91]
  v_and_b32_dpp v104, v54, v44 row_newbcast:12 row_mask:0xf bank_mask:0xf
  v_and_b32_dpp v105, v54, v45 row_newbcast:12 row_mask:0xf bank_mask:0xf
  v_and_b32_dpp v106, v54, v46 row_newbcast:12 row_mask:0xf bank_mask:0xf
  v_and_b32_dpp v107, v54, v47 row_newbcast:12 row_mask:0xf bank_mask:0xf
  s_waitcnt vmcnt(11)
  s_mov_b32 s76, 151552
  buffer_load_dwordx4 a[84:87], v9, s[32:35], s76 offen offset:0 nt
  v_mfma_f32_16x16x32_bf16 v[88:91], v[104:107], a[44:47], v[88:91]
  v_and_b32_dpp v100, v55, v44 row_newbcast:0 row_mask:0xf bank_mask:0xf
  v_and_b32_dpp v101, v55, v45 row_newbcast:0 row_mask:0xf bank_mask:0xf
  v_and_b32_dpp v102, v55, v46 row_newbcast:0 row_mask:0xf bank_mask:0xf
  v_and_b32_dpp v103, v55, v47 row_newbcast:0 row_mask:0xf bank_mask:0xf
  s_waitcnt vmcnt(11)
  s_mov_b32 s76, 155648
  buffer_load_dwordx4 a[88:91], v9, s[32:35], s76 offen offset:0 nt
  v_mfma_f32_16x16x32_bf16 v[88:91], v[100:103], a[48:51], v[88:91]
  v_and_b32_dpp v104, v55, v44 row_newbcast:4 row_mask:0xf bank_mask:0xf
  v_and_b32_dpp v105, v55, v45 row_newbcast:4 row_mask:0xf bank_mask:0xf
  v_and_b32_dpp v106, v55, v46 row_newbcast:4 row_mask:0xf bank_mask:0xf
  v_and_b32_dpp v107, v55, v47 row_newbcast:4 row_mask:0xf bank_mask:0xf
  s_waitcnt vmcnt(11)
  s_mov_b32 s76, 159744
  buffer_load_dwordx4 a[92:95], v9, s[32:35], s76 offen offset:0 nt
  v_mfma_f32_16x16x32_bf16 v[88:91], v[104:107], a[52:55], v[88:91]
  v_and_b32_dpp v100, v55, v44 row_newbcast:8 row_mask:0xf bank_mask:0xf
  v_and_b32_dpp v101, v55, v45 row_newbcast:8 row_mask:0xf bank_mask:0xf
  v_and_b32_dpp v102, v55, v46 row_newbcast:8 row_mask:0xf bank_mask:0xf
  v_and_b32_dpp v103, v55, v47 row_newbcast:8 row_mask:0xf bank_mask:0xf
  s_waitcnt vmcnt(11)
  s_mov_b32 s76, 163840
  buffer_load_dwordx4 a[96:99], v9, s[32:35], s76 offen offset:0 nt
  v_mfma_f32_16x16x32_bf16 v[88:91], v[100:103], a[56:59], v[88:91]
  v_and_b32_dpp v104, v55, v44 row_newbcast:12 row_mask:0xf bank_mask:0xf
  v_and_b32_dpp v105, v55, v45 row_newbcast:12 row_mask:0xf bank_mask:0xf
  v_and_b32_dpp v106, v55, v46 row_newbcast:12 row_mask:0xf bank_mask:0xf
  v_and_b32_dpp v107, v55, v47 row_newbcast:12 row_mask:0xf bank_mask:0xf
  s_waitcnt vmcnt(11)
  s_mov_b32 s76, 167936
  buffer_load_dwordx4 a[100:103], v9, s[32:35], s76 offen offset:0 nt
  v_mfma_f32_16x16x32_bf16 v[88:91], v[104:107], a[60:63], v[88:91]
  v_and_b32_dpp v100, v56, v44 row_newbcast:0 row_mask:0xf bank_mask:0xf
  v_and_b32_dpp v101, v56, v45 row_newbcast:0 row_mask:0xf bank_mask:0xf
  v_and_b32_dpp v102, v56, v46 row_newbcast:0 row_mask:0xf bank_mask:0xf
  v_and_b32_dpp v103, v56, v47 row_newbcast:0 row_mask:0xf bank_mask:0xf
  s_waitcnt vmcnt(11)
  s_mov_b32 s76, 172032
  buffer_load_dwordx4 a[104:107], v9, s[32:35], s76 offen offset:0 nt
  v_mfma_f32_16x16x32_bf16 v[88:91], v[100:103], a[64:67], v[88:91]
  v_and_b32_dpp v104, v56, v44 row_newbcast:4 row_mask:0xf bank_mask:0xf
  v_and_b32_dpp v105, v56, v45 row_newbcast:4 row_mask:0xf bank_mask:0xf
  v_and_b32_dpp v106, v56, v46 row_newbcast:4 row_mask:0xf bank_mask:0xf
  v_and_b32_dpp v107, v56, v47 row_newbcast:4 row_mask:0xf bank_mask:0xf
  s_waitcnt vmcnt(11)
  s_mov_b32 s76, 176128
  buffer_load_dwordx4 a[108:111], v9, s[32:35], s76 offen offset:0 nt
  v_mfma_f32_16x16x32_bf16 v[88:91], v[104:107], a[68:71], v[88:91]
  v_and_b32_dpp v100, v56, v44 row_newbcast:8 row_mask:0xf bank_mask:0xf
  v_and_b32_dpp v101, v56, v45 row_newbcast:8 row_mask:0xf bank_mask:0xf
  v_and_b32_dpp v102, v56, v46 row_newbcast:8 row_mask:0xf bank_mask:0xf
  v_and_b32_dpp v103, v56, v47 row_newbcast:8 row_mask:0xf bank_mask:0xf
  s_waitcnt vmcnt(11)
  s_mov_b32 s76, 180224
  buffer_load_dwordx4 a[112:115], v9, s[32:35], s76 offen offset:0 nt
  v_mfma_f32_16x16x32_bf16 v[88:91], v[100:103], a[72:75], v[88:91]
  v_and_b32_dpp v104, v56, v44 row_newbcast:12 row_mask:0xf bank_mask:0xf
  v_and_b32_dpp v105, v56, v45 row_newbcast:12 row_mask:0xf bank_mask:0xf
  v_and_b32_dpp v106, v56, v46 row_newbcast:12 row_mask:0xf bank_mask:0xf
  v_and_b32_dpp v107, v56, v47 row_newbcast:12 row_mask:0xf bank_mask:0xf
  s_waitcnt vmcnt(11)
  s_mov_b32 s76, 184320
  buffer_load_dwordx4 a[116:119], v9, s[32:35], s76 offen offset:0 nt
  v_mfma_f32_16x16x32_bf16 v[88:91], v[104:107], a[76:79], v[88:91]
  v_and_b32_dpp v100, v57, v44 row_newbcast:0 row_mask:0xf bank_mask:0xf
  v_and_b32_dpp v101, v57, v45 row_newbcast:0 row_mask:0xf bank_mask:0xf
  v_and_b32_dpp v102, v57, v46 row_newbcast:0 row_mask:0xf bank_mask:0xf
  v_and_b32_dpp v103, v57, v47 row_newbcast:0 row_mask:0xf bank_mask:0xf
  s_waitcnt vmcnt(11)
  s_mov_b32 s76, 188416
  buffer_load_dwordx4 a[120:123], v9, s[32:35], s76 offen offset:0 nt
  s_waitcnt vmcnt(11)
  s_mov_b32 s76, 192512
  buffer_load_dwordx4 a[124:127], v9, s[32:35], s76 offen offset:0 nt
  v_max3_u32 v32, v40, v41, v42
  v_cmp_eq_u32 vcc, -1, v32
  v_and_b32 v43, 0x3ff, v43
  v_cmp_gt_u32 s[86:87], 8, v43
  s_nop 3
  s_or_b64 vcc, vcc, s[86:87]
  s_cbranch_vccnz L_r2
L_c2:
  v_mov_b32 v4, v40
  s_nop 1
  v_max_f32_dpp v4, v4, v4 row_ror:8 row_mask:0xf bank_mask:0xf
  s_nop 1
  v_max_f32_dpp v4, v4, v4 row_ror:4 row_mask:0xf bank_mask:0xf
  s_nop 1
  v_max_f32_dpp v4, v4, v4 row_ror:2 row_mask:0xf bank_mask:0xf
  s_nop 1
  v_max_f32_dpp v4, v4, v4 row_ror:1 row_mask:0xf bank_mask:0xf
  v_mov_b32 v5, v4
  s_nop 1
  v_permlane16_swap_b32 v5, v4
  v_max_f32 v4, v5, v4
  v_sub_f32 v40, v40, v4
  v_sub_f32 v22, v36, v4
  v_mul_f32 v40, 0x3fb8aa3b, v40
  v_mul_f32 v22, 0x3fb8aa3b, v22
  v_exp_f32 v40, v40
  v_exp_f32 v22, v22
  v_mul_f32 v40, v40, v41
  s_nop 1
  v_add_f32_dpp v40, v40, v40 row_ror:8 row_mask:0xf bank_mask:0xf
  s_nop 1
  v_add_f32_dpp v40, v40, v40 row_ror:4 row_mask:0xf bank_mask:0xf
  s_nop 1
  v_add_f32_dpp v40, v40, v40 row_ror:2 row_mask:0xf bank_mask:0xf
  s_nop 1
  v_add_f32_dpp v40, v40, v40 row_ror:1 row_mask:0xf bank_mask:0xf
  v_mov_b32 v5, v40
  s_nop 1
  v_permlane16_swap_b32 v5, v40
  v_add_f32 v40, v5, v40
  v_rcp_f32 v40, v40
  s_nop 0
  v_mul_f32 v22, v22, v40
  v_lshlrev_b32 v23, 16, v23
  s_waitcnt vmcnt(11)
  s_mov_b32 s76, 196608
  buffer_load_dwordx4 a[128:131], v9, s[32:35], s76 offen offset:0 nt
  v_mfma_f32_16x16x32_bf16 v[88:91], v[100:103], a[80:83], v[88:91]
  v_and_b32_dpp v104, v57, v44 row_newbcast:4 row_mask:0xf bank_mask:0xf
  v_and_b32_dpp v105, v57, v45 row_newbcast:4 row_mask:0xf bank_mask:0xf
  v_and_b32_dpp v106, v57, v46 row_newbcast:4 row_mask:0xf bank_mask:0xf
  v_and_b32_dpp v107, v57, v47 row_newbcast:4 row_mask:0xf bank_mask:0xf
  s_waitcnt vmcnt(11)
  s_mov_b32 s76, 200704
  buffer_load_dwordx4 a[132:135], v9, s[32:35], s76 offen offset:0 nt
  v_mfma_f32_16x16x32_bf16 v[88:91], v[104:107], a[84:87], v[88:91]
  v_and_b32_dpp v100, v57, v44 row_newbcast:8 row_mask:0xf bank_mask:0xf
  v_and_b32_dpp v101, v57, v45 row_newbcast:8 row_mask:0xf bank_mask:0xf
  v_and_b32_dpp v102, v57, v46 row_newbcast:8 row_mask:0xf bank_mask:0xf
  v_and_b32_dpp v103, v57, v47 row_newbcast:8 row_mask:0xf bank_mask:0xf
  s_waitcnt vmcnt(11)
  s_mov_b32 s76, 204800
  buffer_load_dwordx4 a[136:139], v9, s[32:35], s76 offen offset:0 nt
  v_mfma_f32_16x16x32_bf16 v[88:91], v[100:103], a[88:91], v[88:91]
  v_and_b32_dpp v104, v57, v44 row_newbcast:12 row_mask:0xf bank_mask:0xf
  v_and_b32_dpp v105, v57, v45 row_newbcast:12 row_mask:0xf bank_mask:0xf
  v_and_b32_dpp v106, v57, v46 row_newbcast:12 row_mask:0xf bank_mask:0xf
  v_and_b32_dpp v107, v57, v47 row_newbcast:12 row_mask:0xf bank_mask:0xf
  s_waitcnt vmcnt(11)
  s_mov_b32 s76, 208896
  buffer_load_dwordx4 a[140:143], v9, s[32:35], s76 offen offset:0 nt
  v_mfma_f32_16x16x32_bf16 v[88:91], v[104:107], a[92:95], v[88:91]
  v_and_b32_dpp v100, v58, v44 row_newbcast:0 row_mask:0xf bank_mask:0xf
  v_and_b32_dpp v101, v58, v45 row_newbcast:0 row_mask:0xf bank_mask:0xf
  v_and_b32_dpp v102, v58, v46 row_newbcast:0 row_mask:0xf bank_mask:0xf
  v_and_b32_dpp v103, v58, v47 row_newbcast:0 row_mask:0xf bank_mask:0xf
  s_waitcnt vmcnt(11)
  s_mov_b32 s76, 212992
  buffer_load_dwordx4 a[144:147], v9, s[32:35], s76 offen offset:0 nt
  v_mfma_f32_16x16x32_bf16 v[88:91], v[100:103], a[96:99], v[88:91]
  v_and_b32_dpp v104, v58, v44 row_newbcast:4 row_mask:0xf bank_mask:0xf
  v_and_b32_dpp v105, v58, v45 row_newbcast:4 row_mask:0xf bank_mask:0xf
  v_and_b32_dpp v106, v58, v46 row_newbcast:4 row_mask:0xf bank_mask:0xf
  v_and_b32_dpp v107, v58, v47 row_newbcast:4 row_mask:0xf bank_mask:0xf
  s_waitcnt vmcnt(11)
  s_mov_b32 s76, 217088
  buffer_load_dwordx4 a[148:151], v9, s[32:35], s76 offen offset:0 nt
  v_mfma_f32_16x16x32_bf16 v[88:91], v[104:107], a[100:103], v[88:91]
  v_and_b32_dpp v100, v58, v44 row_newbcast:8 row_mask:0xf bank_mask:0xf
  v_and_b32_dpp v101, v58, v45 row_newbcast:8 row_mask:0xf bank_mask:0xf
  v_and_b32_dpp v102, v58, v46 row_newbcast:8 row_mask:0xf bank_mask:0xf
  v_and_b32_dpp v103, v58, v47 row_newbcast:8 row_mask:0xf bank_mask:0xf
  s_waitcnt vmcnt(11)
  s_mov_b32 s76, 221184
  buffer_load_dwordx4 a[152:155], v9, s[32:35], s76 offen offset:0 nt
  v_mfma_f32_16x16x32_bf16 v[88:91], v[100:103], a[104:107], v[88:91]
  v_and_b32_dpp v104, v58, v44 row_newbcast:12 row_mask:0xf bank_mask:0xf
  v_and_b32_dpp v105, v58, v45 row_newbcast:12 row_mask:0xf bank_mask:0xf
  v_and_b32_dpp v106, v58, v46 row_newbcast:12 row_mask:0xf bank_mask:0xf
  v_and_b32_dpp v107, v58, v47 row_newbcast:12 row_mask:0xf bank_mask:0xf
  s_waitcnt vmcnt(11)
  s_mov_b32 s76, 225280
  buffer_load_dwordx4 a[156:159], v9, s[32:35], s76 offen offset:0 nt
  v_mfma_f32_16x16x32_bf16 v[88:91], v[104:107], a[108:111], v[88:91]
  v_and_b32_dpp v100, v59, v44 row_newbcast:0 row_mask:0xf bank_mask:0xf
  v_and_b32_dpp v101, v59, v45 row_newbcast:0 row_mask:0xf bank_mask:0xf
  v_and_b32_dpp v102, v59, v46 row_newbcast:0 row_mask:0xf bank_mask:0xf
  v_and_b32_dpp v103, v59, v47 row_newbcast:0 row_mask:0xf bank_mask:0xf
  s_waitcnt vmcnt(11)
  s_mov_b32 s76, 229376
  buffer_load_dwordx4 a[160:163], v9, s[32:35], s76 offen offset:0 nt
  v_mfma_f32_16x16x32_bf16 v[88:91], v[100:103], a[112:115], v[88:91]
  v_and_b32_dpp v104, v59, v44 row_newbcast:4 row_mask:0xf bank_mask:0xf
  v_and_b32_dpp v105, v59, v45 row_newbcast:4 row_mask:0xf bank_mask:0xf
  v_and_b32_dpp v106, v59, v46 row_newbcast:4 row_mask:0xf bank_mask:0xf
  v_and_b32_dpp v107, v59, v47 row_newbcast:4 row_mask:0xf bank_mask:0xf
  s_waitcnt vmcnt(11)
  s_mov_b32 s76, 233472
  buffer_load_dwordx4 a[164:167], v9, s[32:35], s76 offen offset:0 nt
  v_mfma_f32_16x16x32_bf16 v[88:91], v[104:107], a[116:119], v[88:91]
  v_and_b32_dpp v100, v59, v44 row_newbcast:8 row_mask:0xf bank_mask:0xf
  v_and_b32_dpp v101, v59, v45 row_newbcast:8 row_mask:0xf bank_mask:0xf
  v_and_b32_dpp v102, v59, v46 row_newbcast:8 row_mask:0xf bank_mask:0xf
  v_and_b32_dpp v103, v59, v47 row_newbcast:8 row_mask:0xf bank_mask:0xf
  s_waitcnt vmcnt(11)
  s_mov_b32 s76, 237568
  buffer_load_dwordx4 a[168:171], v9, s[32:35], s76 offen offset:0 nt
  v_mfma_f32_16x16x32_bf16 v[88:91], v[100:103], a[120:123], v[88:91]
  v_and_b32_dpp v104, v59, v44 row_newbcast:12 row_mask:0xf bank_mask:0xf
  v_and_b32_dpp v105, v59, v45 row_newbcast:12 row_mask:0xf bank_mask:0xf
  v_and_b32_dpp v106, v59, v46 row_newbcast:12 row_mask:0xf bank_mask:0xf
  v_and_b32_dpp v107, v59, v47 row_newbcast:12 row_mask:0xf bank_mask:0xf
  s_waitcnt vmcnt(11)
  s_mov_b32 s76, 241664
  buffer_load_dwordx4 a[172:175], v9, s[32:35], s76 offen offset:0 nt
  v_mfma_f32_16x16x32_bf16 v[88:91], v[104:107], a[124:127], v[88:91]
  v_and_b32_dpp v100, v60, v44 row_newbcast:0 row_mask:0xf bank_mask:0xf
  v_and_b32_dpp v101, v60, v45 row_newbcast:0 row_mask:0xf bank_mask:0xf
  v_and_b32_dpp v102, v60, v46 row_newbcast:0 row_mask:0xf bank_mask:0xf
  v_and_b32_dpp v103, v60, v47 row_newbcast:0 row_mask:0xf bank_mask:0xf
  s_waitcnt vmcnt(11)
  s_mov_b32 s76, 245760
  buffer_load_dwordx4 a[176:179], v9, s[32:35], s76 offen offset:0 nt
  v_mfma_f32_16x16x32_bf16 v[88:91], v[100:103], a[128:131], v[88:91]
  v_and_b32_dpp v104, v60, v44 row_newbcast:4 row_mask:0xf bank_mask:0xf
  v_and_b32_dpp v105, v60, v45 row_newbcast:4 row_mask:0xf bank_mask:0xf
  v_and_b32_dpp v106, v60, v46 row_newbcast:4 row_mask:0xf bank_mask:0xf
  v_and_b32_dpp v107, v60, v47 row_newbcast:4 row_mask:0xf bank_mask:0xf
  s_waitcnt vmcnt(11)
  s_mov_b32 s76, 249856
  buffer_load_dwordx4 a[180:183], v9, s[32:35], s76 offen offset:0 nt
  v_mfma_f32_16x16x32_bf16 v[88:91], v[104:107], a[132:135], v[88:91]
  v_and_b32_dpp v100, v60, v44 row_newbcast:8 row_mask:0xf bank_mask:0xf
  v_and_b32_dpp v101, v60, v45 row_newbcast:8 row_mask:0xf bank_mask:0xf
  v_and_b32_dpp v102, v60, v46 row_newbcast:8 row_mask:0xf bank_mask:0xf
  v_and_b32_dpp v103, v60, v47 row_newbcast:8 row_mask:0xf bank_mask:0xf
  s_waitcnt vmcnt(11)
  s_mov_b32 s76, 253952
  buffer_load_dwordx4 a[184:187], v9, s[32:35], s76 offen offset:0 nt
  v_mfma_f32_16x16x32_bf16 v[88:91], v[100:103], a[136:139], v[88:91]
  v_and_b32_dpp v104, v60, v44 row_newbcast:12 row_mask:0xf bank_mask:0xf
  v_and_b32_dpp v105, v60, v45 row_newbcast:12 row_mask:0xf bank_mask:0xf
  v_and_b32_dpp v106, v60, v46 row_newbcast:12 row_mask:0xf bank_mask:0xf
  v_and_b32_dpp v107, v60, v47 row_newbcast:12 row_mask:0xf bank_mask:0xf
  s_waitcnt vmcnt(11)
  s_mov_b32 s76, 258048
  buffer_load_dwordx4 a[188:191], v9, s[32:35], s76 offen offset:0 nt
  v_mfma_f32_16x16x32_bf16 v[88:91], v[104:107], a[140:143], v[88:91]
  v_and_b32_dpp v100, v61, v44 row_newbcast:0 row_mask:0xf bank_mask:0xf
  v_and_b32_dpp v101, v61, v45 row_newbcast:0 row_mask:0xf bank_mask:0xf
  v_and_b32_dpp v102, v61, v46 row_newbcast:0 row_mask:0xf bank_mask:0xf
  v_and_b32_dpp v103, v61, v47 row_newbcast:0 row_mask:0xf bank_mask:0xf
  s_waitcnt vmcnt(11)
  s_lshl_b32 s72, s62, 7
  s_lshl_b32 s73, s64, 5
  s_addk_i32 s73, 0
  s_add_u32 s72, s72, s73
  s_mul_i32 s72, s72, 1152
  buffer_load_dwordx4 v[164:167], v10, s[40:43], s72 offen nt
  v_mfma_f32_16x16x32_bf16 v[88:91], v[100:103], a[144:147], v[88:91]
  v_and_b32_dpp v104, v61, v44 row_newbcast:4 row_mask:0xf bank_mask:0xf
  v_and_b32_dpp v105, v61, v45 row_newbcast:4 row_mask:0xf bank_mask:0xf
  v_and_b32_dpp v106, v61, v46 row_newbcast:4 row_mask:0xf bank_mask:0xf
  v_and_b32_dpp v107, v61, v47 row_newbcast:4 row_mask:0xf bank_mask:0xf
  s_waitcnt vmcnt(11)
  s_lshl_b32 s72, s62, 7
  s_lshl_b32 s73, s64, 5
  s_addk_i32 s73, 4
  s_add_u32 s72, s72, s73
  s_mul_i32 s72, s72, 1152
  buffer_load_dwordx4 v[168:171], v10, s[40:43], s72 offen nt
  v_mfma_f32_16x16x32_bf16 v[88:91], v[104:107], a[148:151], v[88:91]
  v_and_b32_dpp v100, v61, v44 row_newbcast:8 row_mask:0xf bank_mask:0xf
  v_and_b32_dpp v101, v61, v45 row_newbcast:8 row_mask:0xf bank_mask:0xf
  v_and_b32_dpp v102, v61, v46 row_newbcast:8 row_mask:0xf bank_mask:0xf
  v_and_b32_dpp v103, v61, v47 row_newbcast:8 row_mask:0xf bank_mask:0xf
  s_waitcnt vmcnt(11)
  s_lshl_b32 s72, s62, 7
  s_lshl_b32 s73, s64, 5
  s_addk_i32 s73, 8
  s_add_u32 s72, s72, s73
  s_mul_i32 s72, s72, 1152
  buffer_load_dwordx4 v[172:175], v10, s[40:43], s72 offen nt
  v_mfma_f32_16x16x32_bf16 v[88:91], v[100:103], a[152:155], v[88:91]
  v_and_b32_dpp v104, v61, v44 row_newbcast:12 row_mask:0xf bank_mask:0xf
  v_and_b32_dpp v105, v61, v45 row_newbcast:12 row_mask:0xf bank_mask:0xf
  v_and_b32_dpp v106, v61, v46 row_newbcast:12 row_mask:0xf bank_mask:0xf
  v_and_b32_dpp v107, v61, v47 row_newbcast:12 row_mask:0xf bank_mask:0xf
  s_waitcnt vmcnt(11)
  s_lshl_b32 s72, s62, 7
  s_lshl_b32 s73, s64, 5
  s_addk_i32 s73, 12
  s_add_u32 s72, s72, s73
  s_mul_i32 s72, s72, 1152
  buffer_load_dwordx4 v[176:179], v10, s[40:43], s72 offen nt
  v_mfma_f32_16x16x32_bf16 v[88:91], v[104:107], a[156:159], v[88:91]
  v_and_b32_dpp v100, v62, v44 row_newbcast:0 row_mask:0xf bank_mask:0xf
  v_and_b32_dpp v101, v62, v45 row_newbcast:0 row_mask:0xf bank_mask:0xf
  v_and_b32_dpp v102, v62, v46 row_newbcast:0 row_mask:0xf bank_mask:0xf
  v_and_b32_dpp v103, v62, v47 row_newbcast:0 row_mask:0xf bank_mask:0xf
  s_waitcnt vmcnt(11)
  s_lshl_b32 s72, s62, 7
  s_lshl_b32 s73, s64, 5
  s_addk_i32 s73, 16
  s_add_u32 s72, s72, s73
  s_mul_i32 s72, s72, 1152
  buffer_load_dwordx4 v[180:183], v10, s[40:43], s72 offen nt
  v_mfma_f32_16x16x32_bf16 v[88:91], v[100:103], a[160:163], v[88:91]
  v_and_b32_dpp v104, v62, v44 row_newbcast:4 row_mask:0xf bank_mask:0xf
  v_and_b32_dpp v105, v62, v45 row_newbcast:4 row_mask:0xf bank_mask:0xf
  v_and_b32_dpp v106, v62, v46 row_newbcast:4 row_mask:0xf bank_mask:0xf
  v_and_b32_dpp v107, v62, v47 row_newbcast:4 row_mask:0xf bank_mask:0xf
  s_waitcnt vmcnt(11)
  s_lshl_b32 s72, s62, 7
  s_lshl_b32 s73, s64, 5
  s_addk_i32 s73, 20
  s_add_u32 s72, s72, s73
  s_mul_i32 s72, s72, 1152
  buffer_load_dwordx4 v[184:187], v10, s[40:43], s72 offen nt
  v_mfma_f32_16x16x32_bf16 v[88:91], v[104:107], a[164:167], v[88:91]
  v_and_b32_dpp v100, v62, v44 row_newbcast:8 row_mask:0xf bank_mask:0xf
  v_and_b32_dpp v101, v62, v45 row_newbcast:8 row_mask:0xf bank_mask:0xf
  v_and_b32_dpp v102, v62, v46 row_newbcast:8 row_mask:0xf bank_mask:0xf
  v_and_b32_dpp v103, v62, v47 row_newbcast:8 row_mask:0xf bank_mask:0xf
  s_waitcnt vmcnt(11)
  s_lshl_b32 s72, s62, 7
  s_lshl_b32 s73, s64, 5
  s_addk_i32 s73, 24
  s_add_u32 s72, s72, s73
  s_mul_i32 s72, s72, 1152
  buffer_load_dwordx4 v[188:191], v10, s[40:43], s72 offen nt
  v_mfma_f32_16x16x32_bf16 v[88:91], v[100:103], a[168:171], v[88:91]
  v_and_b32_dpp v104, v62, v44 row_newbcast:12 row_mask:0xf bank_mask:0xf
  v_and_b32_dpp v105, v62, v45 row_newbcast:12 row_mask:0xf bank_mask:0xf
  v_and_b32_dpp v106, v62, v46 row_newbcast:12 row_mask:0xf bank_mask:0xf
  v_and_b32_dpp v107, v62, v47 row_newbcast:12 row_mask:0xf bank_mask:0xf
  s_waitcnt vmcnt(11)
  s_lshl_b32 s72, s62, 7
  s_lshl_b32 s73, s64, 5
  s_addk_i32 s73, 28
  s_add_u32 s72, s72, s73
  s_mul_i32 s72, s72, 1152
  buffer_load_dwordx4 v[192:195], v10, s[40:43], s72 offen nt
  v_mfma_f32_16x16x32_bf16 v[88:91], v[104:107], a[172:175], v[88:91]
  v_and_b32_dpp v100, v63, v44 row_newbcast:0 row_mask:0xf bank_mask:0xf
  v_and_b32_dpp v101, v63, v45 row_newbcast:0 row_mask:0xf bank_mask:0xf
  v_and_b32_dpp v102, v63, v46 row_newbcast:0 row_mask:0xf bank_mask:0xf
  v_and_b32_dpp v103, v63, v47 row_newbcast:0 row_mask:0xf bank_mask:0xf
  s_waitcnt vmcnt(11)
  s_nop 0
  v_mfma_f32_16x16x32_bf16 v[88:91], v[100:103], a[176:179], v[88:91]
  v_and_b32_dpp v104, v63, v44 row_newbcast:4 row_mask:0xf bank_mask:0xf
  v_and_b32_dpp v105, v63, v45 row_newbcast:4 row_mask:0xf bank_mask:0xf
  v_and_b32_dpp v106, v63, v46 row_newbcast:4 row_mask:0xf bank_mask:0xf
  v_and_b32_dpp v107, v63, v47 row_newbcast:4 row_mask:0xf bank_mask:0xf
  s_waitcnt vmcnt(10)
  s_nop 0
  v_mfma_f32_16x16x32_bf16 v[88:91], v[104:107], a[180:183], v[88:91]
  v_and_b32_dpp v100, v63, v44 row_newbcast:8 row_mask:0xf bank_mask:0xf
  v_and_b32_dpp v101, v63, v45 row_newbcast:8 row_mask:0xf bank_mask:0xf
  v_and_b32_dpp v102, v63, v46 row_newbcast:8 row_mask:0xf bank_mask:0xf
  v_and_b32_dpp v103, v63, v47 row_newbcast:8 row_mask:0xf bank_mask:0xf
  s_waitcnt vmcnt(9)
  s_nop 0
  v_mfma_f32_16x16x32_bf16 v[88:91], v[100:103], a[184:187], v[88:91]
  v_and_b32_dpp v104, v63, v44 row_newbcast:12 row_mask:0xf bank_mask:0xf
  v_and_b32_dpp v105, v63, v45 row_newbcast:12 row_mask:0xf bank_mask:0xf
  v_and_b32_dpp v106, v63, v46 row_newbcast:12 row_mask:0xf bank_mask:0xf
  v_and_b32_dpp v107, v63, v47 row_newbcast:12 row_mask:0xf bank_mask:0xf
  s_waitcnt vmcnt(8)
  s_nop 0
  v_mfma_f32_16x16x32_bf16 v[88:91], v[104:107], a[188:191], v[88:91]
  s_nop 7
  v_mul_f32 v88, v22, v88
  v_mul_f32 v89, v22, v89
  v_mul_f32 v90, v22, v90
  v_mul_f32 v91, v22, v91
  s_mov_b32 exec_hi, 0
  ds_write_b128 v14, v[88:91] offset:256
  s_mov_b64 exec, -1
  s_waitcnt lgkmcnt(0)
  s_barrier
  s_cmp_lg_u32 s64, 0
  s_cbranch_scc1 L_ored
  s_mov_b32 exec_hi, 0
  ds_read_b128 v[132:135], v14 offset:768
  ds_read_b128 v[136:139], v14 offset:1280
  ds_read_b128 v[140:143], v14 offset:1792
  s_waitcnt lgkmcnt(2)
  v_pk_add_f32 v[88:89], v[88:89], v[132:133]
  v_pk_add_f32 v[90:91], v[90:91], v[134:135]
  s_waitcnt lgkmcnt(0)
  v_pk_add_f32 v[136:137], v[136:137], v[140:141]
  v_pk_add_f32 v[138:139], v[138:139], v[142:143]
  v_pk_add_f32 v[88:89], v[88:89], v[136:137]
  v_pk_add_f32 v[90:91], v[90:91], v[138:139]
  s_mov_b64 exec, -1
  s_cmp_eq_u32 s89, 0
  s_cbranch_scc1 L_faro
  buffer_store_dwordx4 v[88:91], v11, s[48:51], s79 offen
  s_branch L_sto
L_faro:
  buffer_store_dwordx4 v[88:91], v11, s[48:51], s79 offen sc0 sc1
L_sto:
L_ored:
  s_waitcnt vmcnt(0)
  s_mov_b32 s77, 400000
L_p1:
  buffer_load_dwordx4 v[132:135], v18, s[48:51], s92 offen sc1
  s_waitcnt vmcnt(0)
  v_max3_u32 v4, v132, v133, v134
  v_max_u32 v4, v4, v135
  v_cmp_eq_u32 vcc, -1, v4
  s_cbranch_vccz L_g1
  s_sub_u32 s77, s77, 1
  s_cmp_lg_u32 s77, 0
  s_cbranch_scc1 L_p1
L_g1:
  v_permlane32_swap_b32 v132, v134
  v_permlane32_swap_b32 v133, v135
  v_add_f32 v132, v132, v134
  v_add_f32 v133, v133, v135
  s_nop 1
  v_permlane16_swap_b32 v132, v133
  v_add_f32 v132, v132, v133
  s_nop 1
  v_add_f32_dpp v132, v132, v132 row_ror:8 row_mask:0xf bank_mask:0xf
  v_cvt_pk_bf16_f32 v114, v132, v132
  s_nop 1
  v_and_b32_dpp v100, v114, v44 row_newbcast:0 row_mask:0xf bank_mask:0xf
  v_and_b32_dpp v101, v114, v45 row_newbcast:0 row_mask:0xf bank_mask:0xf
  v_and_b32_dpp v102, v114, v46 row_newbcast:0 row_mask:0xf bank_mask:0xf
  v_and_b32_dpp v103, v114, v47 row_newbcast:0 row_mask:0xf bank_mask:0xf
  v_and_b32_dpp v104, v114, v44 row_newbcast:1 row_mask:0xf bank_mask:0xf
  v_and_b32_dpp v105, v114, v45 row_newbcast:1 row_mask:0xf bank_mask:0xf
  v_and_b32_dpp v106, v114, v46 row_newbcast:1 row_mask:0xf bank_mask:0xf
  v_and_b32_dpp v107, v114, v47 row_newbcast:1 row_mask:0xf bank_mask:0xf
  v_mfma_f32_16x16x32_bf16 v[92:95], v[100:103], v[164:167], v[92:95]
  v_and_b32_dpp v152, v114, v44 row_newbcast:2 row_mask:0xf bank_mask:0xf
  v_and_b32_dpp v153, v114, v45 row_newbcast:2 row_mask:0xf bank_mask:0xf
  v_and_b32_dpp v154, v114, v46 row_newbcast:2 row_mask:0xf bank_mask:0xf
  v_and_b32_dpp v155, v114, v47 row_newbcast:2 row_mask:0xf bank_mask:0xf
  v_mfma_f32_16x16x32_bf16 v[92:95], v[104:107], v[168:171], v[92:95]
  v_and_b32_dpp v156, v114, v44 row_newbcast:3 row_mask:0xf bank_mask:0xf
  v_and_b32_dpp v157, v114, v45 row_newbcast:3 row_mask:0xf bank_mask:0xf
  v_and_b32_dpp v158, v114, v46 row_newbcast:3 row_mask:0xf bank_mask:0xf
  v_and_b32_dpp v159, v114, v47 row_newbcast:3 row_mask:0xf bank_mask:0xf
  v_mfma_f32_16x16x32_bf16 v[92:95], v[152:155], v[172:175], v[92:95]
  v_and_b32_dpp v136, v114, v44 row_newbcast:4 row_mask:0xf bank_mask:0xf
  v_and_b32_dpp v137, v114, v45 row_newbcast:4 row_mask:0xf bank_mask:0xf
  v_and_b32_dpp v138, v114, v46 row_newbcast:4 row_mask:0xf bank_mask:0xf
  v_and_b32_dpp v139, v114, v47 row_newbcast:4 row_mask:0xf bank_mask:0xf
  v_mfma_f32_16x16x32_bf16 v[92:95], v[156:159], v[176:179], v[92:95]
  v_and_b32_dpp v140, v114, v44 row_newbcast:5 row_mask:0xf bank_mask:0xf
  v_and_b32_dpp v141, v114, v45 row_newbcast:5 row_mask:0xf bank_mask:0xf
  v_and_b32_dpp v142, v114, v46 row_newbcast:5 row_mask:0xf bank_mask:0xf
  v_and_b32_dpp v143, v114, v47 row_newbcast:5 row_mask:0xf bank_mask:0xf
  v_mfma_f32_16x16x32_bf16 v[92:95], v[136:139], v[180:183], v[92:95]
  v_and_b32_dpp v144, v114, v44 row_newbcast:6 row_mask:0xf bank_mask:0xf
  v_and_b32_dpp v145, v114, v45 row_newbcast:6 row_mask:0xf bank_mask:0xf
  v_and_b32_dpp v146, v114, v46 row_newbcast:6 row_mask:0xf bank_mask:0xf
  v_and_b32_dpp v147, v114, v47 row_newbcast:6 row_mask:0xf bank_mask:0xf
  v_mfma_f32_16x16x32_bf16 v[92:95], v[140:143], v[184:187], v[92:95]
  v_and_b32_dpp v80, v114, v44 row_newbcast:7 row_mask:0xf bank_mask:0xf
  v_and_b32_dpp v81, v114, v45 row_newbcast:7 row_mask:0xf bank_mask:0xf
  v_and_b32_dpp v82, v114, v46 row_newbcast:7 row_mask:0xf bank_mask:0xf
  v_and_b32_dpp v83, v114, v47 row_newbcast:7 row_mask:0xf bank_mask:0xf
  v_mfma_f32_16x16x32_bf16 v[92:95], v[144:147], v[188:191], v[92:95]
  s_nop 0
  v_mfma_f32_16x16x32_bf16 v[92:95], v[80:83], v[192:195], v[92:95]
  s_mov_b32 exec_hi, 0
  s_nop 6
  ds_write_b128 v14, v[92:95] offset:2560
  s_mov_b64 exec, -1
  s_waitcnt lgkmcnt(0)
  s_barrier
  s_cmp_lg_u32 s64, 0
  s_cbranch_scc1 L_yred
  s_mov_b32 exec_hi, 0
  ds_read_b128 v[132:135], v14 offset:3072
  ds_read_b128 v[136:139], v14 offset:3584
  ds_read_b128 v[140:143], v14 offset:4096
  s_waitcnt lgkmcnt(2)
  v_pk_add_f32 v[92:93], v[92:93], v[132:133]
  v_pk_add_f32 v[94:95], v[94:95], v[134:135]
  s_waitcnt lgkmcnt(0)
  v_pk_add_f32 v[136:137], v[136:137], v[140:141]
  v_pk_add_f32 v[138:139], v[138:139], v[142:143]
  v_pk_add_f32 v[92:93], v[92:93], v[136:137]
  v_pk_add_f32 v[94:95], v[94:95], v[138:139]
  s_mov_b64 exec, -1
  buffer_store_dwordx4 v[92:95], v13, s[48:51], s81 offen sc0 sc1
L_yred:
  s_cmp_lg_u32 s64, 1
  s_cbranch_scc1 L_fin
  s_cmp_ge_u32 s62, 9
  s_cbranch_scc1 L_fin
  s_mov_b32 s77, 400000
L_p2:
  buffer_load_dwordx4 v[132:135], v17, s[48:51], s82 offen sc1
  s_waitcnt vmcnt(0)
  v_max3_u32 v4, v132, v133, v134
  v_max_u32 v4, v4, v135
  v_cmp_eq_u32 vcc, -1, v4
  s_cbranch_vccz L_g2
  s_sub_u32 s77, s77, 1
  s_cmp_lg_u32 s77, 0
  s_cbranch_scc1 L_p2
L_g2:
  v_permlane32_swap_b32 v132, v134
  v_permlane32_swap_b32 v133, v135
  v_add_f32 v132, v132, v134
  v_add_f32 v133, v133, v135
  s_nop 1
  v_permlane16_swap_b32 v132, v133
  v_add_f32 v132, v132, v133
  s_nop 1
  v_add_f32_dpp v132, v132, v132 row_ror:8 row_mask:0xf bank_mask:0xf
  s_nop 1
  v_add_f32_dpp v132, v132, v132 row_ror:4 row_mask:0xf bank_mask:0xf
  s_nop 1
  v_add_f32_dpp v132, v132, v132 row_ror:2 row_mask:0xf bank_mask:0xf
  v_add_f32 v132, v132, v23
  v_cvt_pk_bf16_f32 v132, v132, v132
  buffer_store_short v132, v16, s[52:55], s85 offen
L_fin:
  s_endpgm
L_r1:
  s_nop 7
  s_mov_b32 s74, 400000
L_r1a:
  v_and_b32 v5, 3, v1
  v_lshlrev_b32 v5, 3, v5
  buffer_load_dword v6, v5, s[56:59], s97 offen offset:0 sc1
  s_waitcnt vmcnt(0)
  v_and_b32 v5, 0x3ff, v6
  v_cmp_gt_u32 vcc, 8, v5
  s_nop 7
  s_cbranch_vccz L_r1b
  s_sub_u32 s74, s74, 1
  s_cmp_lg_u32 s74, 0
  s_cbranch_scc1 L_r1a
L_r1b:
  v_cmp_ne_u32 vcc, s14, v6
  s_nop 7
  s_cbranch_vccz L_c1
  s_mov_b32 s89, 0
  buffer_store_dwordx4 v[108:111], v15, s[48:51], s90 offen sc0 sc1
  buffer_store_dwordx4 v[96:99], v12, s[48:51], s78 offen sc0 sc1
  s_waitcnt vmcnt(0)
  s_barrier
  s_cmp_lg_u32 s64, 0
  s_cbranch_scc1 L_r1c
  s_add_u32 s74, s91, 4
  s_mov_b32 s93, 1
  s_atomic_add s93, s[24:25], s74
  s_waitcnt lgkmcnt(0)
L_r1c:
  s_mov_b32 s74, 400000
L_r1d:
  v_and_b32 v5, 3, v1
  v_lshlrev_b32 v5, 3, v5
  buffer_load_dword v6, v5, s[56:59], s97 offen offset:4 sc1
  s_waitcnt vmcnt(0)
  v_and_b32 v5, 0x3ff, v6
  v_cmp_gt_u32 vcc, 8, v5
  s_nop 7
  s_cbranch_vccz L_c1
  s_sub_u32 s74, s74, 1
  s_cmp_lg_u32 s74, 0
  s_cbranch_scc1 L_r1d
  s_branch L_c1
L_r2:
  s_nop 7
  s_mov_b32 s74, 400000
L_r2_l:
  buffer_load_dwordx3 v[40:42], v30, s[48:51], s84 offen sc1
  buffer_load_dword v43, v31, s[56:59], 0 offen sc1
  s_waitcnt vmcnt(0)
  v_max3_u32 v32, v40, v41, v42
  v_cmp_eq_u32 vcc, -1, v32
  v_and_b32 v43, 0x3ff, v43
  v_cmp_gt_u32 s[86:87], 8, v43
  s_nop 3
  s_or_b64 vcc, vcc, s[86:87]
  s_nop 7
  s_cbranch_vccz L_c2
  s_sub_u32 s74, s74, 1
  s_cmp_lg_u32 s74, 0
  s_cbranch_scc1 L_r2_l
  s_branch L_c2
L_end:
  s_endpgm
.section .rodata,"a"
.p2align 6
.amdhsa_kernel parallel_sum__mha_block_cached__glu_gated_reglu__decode_kernel
  .amdhsa_next_free_vgpr 512
  .amdhsa_next_free_sgpr 102
  .amdhsa_accum_offset 256
  .amdhsa_group_segment_fixed_size 0
  .amdhsa_kernarg_size 96
  .amdhsa_user_sgpr_count 2
  .amdhsa_user_sgpr_kernarg_segment_ptr 1
  .amdhsa_system_sgpr_workgroup_id_x 1
  .amdhsa_float_denorm_mode_32 3
.end_amdhsa_kernel
```
